```python
import torch

def _softmax(x, axis=-1):
    return torch.softmax(x, dim=axis)
def _gelu(x):
    return torch.nn.functional.gelu(x, approximate="tanh")
def _silu(x):
    return torch.nn.functional.silu(x)
def _sigmoid(x):
    return torch.sigmoid(x)
def _layernorm(x, axis=-1, eps=1e-5):
    m = x.mean(dim=axis, keepdim=True)
    v = x.var(dim=axis, keepdim=True, unbiased=False)
    return (x - m) / torch.sqrt(v + eps)
def _scatter_add(tgt, idx, src, axis=0):
    return tgt.clone().index_add_(axis, idx, src)
def _segment_sum(src, seg, n):
    out = torch.zeros((n,) + src.shape[1:], dtype=src.dtype)
    return out.index_add_(0, seg, src)
def _pad(x, pw):
    flat = tuple(v for pair in reversed(pw) for v in pair)
    return torch.nn.functional.pad(x, flat)

kernel_name = 'standalone__mha_block_cached__near_ridge'

def setup_inputs():

    _w = (lambda a: (lambda t: t.to(torch.bfloat16) if t.is_floating_point() else t)(torch.as_tensor(a)))
    B, Sq, D = 8, 160, 512
    H, Sk, Dh = 32, 512, 128
    return {
        "x": _w((lambda *s: torch.randn(*s, dtype=torch.bfloat16) * 0.8)(B, Sq, D)),
        "k_cache": _w((lambda *s: torch.randn(*s, dtype=torch.bfloat16) * 0.8)(B, H, Sk, Dh)),
        "v_cache": _w((lambda *s: torch.randn(*s, dtype=torch.bfloat16) * 0.05)(B, H, Sk, Dh)),
        "wq": _w((lambda *s: torch.randn(*s, dtype=torch.bfloat16) * 0.8)(D, H * Dh) * (D ** -0.5)),
        "wo": _w((lambda *s: torch.randn(*s, dtype=torch.bfloat16) * 0.05)(H * Dh, D) * ((H * Dh) ** -0.5)),
    }

def reference(x, k_cache, v_cache, wq, wo):
    B, Sq, D = x.shape
    H, Dh = 32, 128
    q = (lambda x, *d: x.permute(*d))((x @ wq).reshape(B, Sq, H, Dh), 0, 2, 1, 3)
    scores = torch.einsum("bhqd,bhkd->bhqk", q, k_cache) * (Dh ** -0.5)
    p = _softmax(scores, axis=-1)
    o = torch.einsum("bhqk,bhkd->bhqd", p, v_cache)
    return (lambda x, *d: x.permute(*d))(o, 0, 2, 1, 3).reshape(B, Sq, H * Dh) @ wo
```

```asm
; @launch grid=(256,1,1) block=(256,1,1) lds=163840
.amdgcn_target "amdgcn-amd-amdhsa--gfx950"
.text
.globl standalone__mha_block_cached__near_ridge_kernel
.p2align 8
.type standalone__mha_block_cached__near_ridge_kernel,@function
standalone__mha_block_cached__near_ridge_kernel:
    s_cmp_ge_u32 s2, 256
    s_cbranch_scc1 L_end
    s_load_dwordx8 s[4:11], s[0:1], 0
    s_load_dwordx8 s[12:19], s[0:1], 32
    s_memrealtime s[68:69]
    v_lshrrev_b32 v22, 6, v0
    s_getpc_b64 s[58:59]
    s_and_b32 s65, s2, 0xf8
    s_lshl_b32 s65, s65, 6
    v_and_b32 v249, 1, v0
    v_lshl_add_u32 v249, v249, 14, s65
    v_lshl_add_u32 v249, v22, 7, v249
    global_load_dword v251, v249, s[58:59]
    v_and_b32 v1, 63, v0
    v_readfirstlane_b32 s3, v22
    s_and_b32 s52, s2, 7
    s_lshr_b32 s53, s2, 5
    s_bfe_u32 s54, s2, 0x20003
    s_and_b32 s55, s3, 1
    s_add_u32 s57, s54, s53
    s_mul_i32 s58, s57, 11
    s_lshr_b32 s58, s58, 5
    s_mul_i32 s58, s58, 3
    s_sub_u32 s57, s57, s58
    s_mul_i32 s57, s57, 3
    s_mul_i32 s58, s52, 1
    s_add_u32 s57, s57, s58
    s_and_b32 s57, s57, 7
    s_lshl_b32 s61, s3, 12
    s_mul_i32 s62, s3, 5120
    s_add_u32 s62, s62, 53248
    s_add_u32 s63, s61, 73728
    v_lshrrev_b32 v244, 4, v1
    v_and_b32 v245, 15, v1
    v_and_b32 v248, 7, v1
    v_xor_b32 v248, v248, v244
    s_lshl_b32 s58, s55, 2
    v_xor_b32 v248, s58, v248
    v_lshlrev_b32 v248, 4, v248
    v_lshrrev_b32 v249, 3, v1
    v_lshl_add_u32 v24, v249, 10, v248
    v_xor_b32 v248, 64, v24
    v_add_u32 v25, 7168, v248
    v_add_u32 v26, 14336, v24
    v_add_u32 v27, 21504, v248
    v_add_u32 v28, 32768, v24
    v_lshlrev_b32 v248, 2, v244
    v_xor_b32 v248, v248, v245
    v_lshlrev_b32 v248, 4, v248
    v_lshl_add_u32 v29, v244, 13, v248
    v_add_u32 v30, 31744, v29
    v_add_u32 v31, 63488, v29
    v_add_u32 v32, 95232, v29
    s_lshr_b32 s56, s3, 1
    v_bfe_u32 v246, v1, 2, 2
    v_and_b32 v247, 3, v1
    v_lshrrev_b32 v249, 1, v245
    v_xor_b32 v249, v249, v244
    v_lshlrev_b32 v249, 4, v249
    v_lshl_add_u32 v249, v245, 7, v249
    s_mul_i32 s58, s56, 10240
    s_add_u32 s58, s58, 53248
    v_add_u32 v33, s58, v249
    v_xor_b32 v34, 64, v33
    v_add_u32 v35, 73728, v33
    v_add_u32 v36, 73728, v34
    s_lshl_b32 s58, s55, 1
    v_xor_b32 v249, s58, v246
    v_lshl_add_u32 v249, v249, 2, v247
    v_lshlrev_b32 v249, 4, v249
    v_lshl_add_u32 v250, v244, 3, v246
    v_lshl_add_u32 v249, v250, 8, v249
    v_add_u32 v37, 73728, v249
    v_xor_b32 v38, 64, v37
    v_add_u32 v39, 73728, v37
    v_add_u32 v40, 73728, v38
    s_mul_i32 s58, s53, 163840
    s_mul_i32 s59, s3, 40960
    s_add_u32 s58, s58, s59
    s_lshl_b32 s60, s52, 2
    s_add_u32 s60, s60, s54
    s_lshl_b32 s65, s60, 8
    s_lshl_b32 s59, s3, 17
    s_add_u32 s65, s65, s59
    s_waitcnt lgkmcnt(0)
    s_add_u32 s20, s4, s58
    s_addc_u32 s21, s5, 0
    s_and_b32 s21, s21, 0xffff
    s_sub_u32 s22, 0x140000, s58
    s_mov_b32 s23, 0x20000
    s_add_u32 s32, s10, s65
    s_addc_u32 s33, s11, 0
    s_and_b32 s33, s33, 0xffff
    s_sub_u32 s34, 0x400000, s65
    s_mov_b32 s35, 0x20000
    s_lshl_b32 s58, s57, 7
    s_add_u32 m0, s62, 36864
    s_lshl_b32 s59, s57, 19
    buffer_load_dwordx4 v24, s[20:23], s58 offen offset:0 lds
    buffer_load_dwordx4 v25, s[20:23], s58 offen offset:1024 lds
    buffer_load_dwordx4 v26, s[20:23], s58 offen offset:2048 lds
    buffer_load_dwordx4 v27, s[20:23], s58 offen offset:3072 lds
    s_add_u32 m0, s62, 40960
    s_add_u32 s57, s57, 1
    buffer_load_dwordx4 v28, s[20:23], s58 offen lds
    s_add_u32 m0, s63, 36864
    s_and_b32 s57, s57, 7
    buffer_load_dwordx4 v29, s[32:35], s59 offen offset:0 nt lds
    buffer_load_dwordx4 v30, s[32:35], s59 offen offset:1024 nt lds
    buffer_load_dwordx4 v31, s[32:35], s59 offen offset:2048 nt lds
    buffer_load_dwordx4 v32, s[32:35], s59 offen offset:3072 nt lds
    s_lshl_b32 s58, s53, 5
    s_add_u32 s58, s58, s60
    s_lshl_b32 s58, s58, 17
    s_add_u32 s60, s58, s61
    s_add_u32 s24, s6, s60
    s_addc_u32 s25, s7, 0
    s_and_b32 s25, s25, 0xffff
    s_sub_u32 s26, 0x2000000, s60
    s_mov_b32 s27, 0x20000
    s_add_u32 s28, s8, s60
    s_addc_u32 s29, s9, 0
    s_and_b32 s29, s29, 0xffff
    s_sub_u32 s30, 0x2000000, s60
    s_mov_b32 s31, 0x20000
    s_lshl_b32 s58, s52, 19
    s_lshl_b32 s59, s54, 8
    s_add_u32 s58, s58, s59
    s_lshl_b32 s59, s3, 14
    s_add_u32 s58, s58, s59
    s_add_u32 s36, s12, s58
    s_addc_u32 s37, s13, 0
    s_and_b32 s37, s37, 0xffff
    s_sub_u32 s38, 0x400000, s58
    s_mov_b32 s39, 0x20000
    s_mov_b32 s40, s14
    s_and_b32 s41, s15, 0xffff
    s_mov_b32 s42, 0x140000
    s_mov_b32 s43, 0x20000
    s_mov_b32 s44, s16
    s_and_b32 s45, s17, 0xffff
    s_mov_b32 s46, 0x100
    s_mov_b32 s47, 0x20000
    s_mov_b32 s48, s18
    s_and_b32 s49, s19, 0xffff
    s_mov_b32 s50, 0x10000000
    s_mov_b32 s51, 0x20000
    s_or_b32 s68, s68, 1
    s_or_b32 s69, s69, 0x80000000
    v_mov_b32 v22, s68
    v_mov_b32 v23, s69
    v_or_b32 v41, s2, v0
    v_lshlrev_b32 v41, 8, v41
    s_mov_b32 s64, 0
    s_xor_b32 s6, s54, 0
    s_lshl_b32 s6, s6, 17
    s_xor_b32 s7, s54, 1
    s_lshl_b32 s7, s7, 17
    s_xor_b32 s8, s54, 2
    s_lshl_b32 s8, s8, 17
    s_xor_b32 s9, s54, 3
    s_lshl_b32 s9, s9, 17
    v_lshlrev_b32 v21, 4, v1
    s_lshl_b32 s58, s3, 2
    v_xor_b32 v248, v245, v244
    v_xor_b32 v249, s58, v248
    v_lshlrev_b32 v249, 4, v249
    v_lshl_add_u32 v2, v244, 8, v249
    s_lshl_b32 s58, s55, 3
    v_lshlrev_b32 v249, 1, v244
    v_xor_b32 v249, v249, v245
    v_lshlrev_b32 v250, 4, v249
    v_lshl_add_u32 v4, v244, 10, v250
    v_xor_b32 v255, 128, v4
    v_xor_b32 v249, s58, v249
    v_lshlrev_b32 v249, 4, v249
    v_lshl_add_u32 v3, v244, 8, v249
    v_lshlrev_b32 v249, 4, v248
    s_lshl_b32 s58, s55, 7
    v_xor_b32 v249, s58, v249
    v_lshl_add_u32 v249, v246, 12, v249
    v_lshl_add_u32 v249, v247, 8, v249
    s_lshl_b32 s59, s55, 11
    v_add_u32 v7, s59, v249
    v_xor_b32 v8, 64, v7
    v_xor_b32 v9, 128, v7
    v_xor_b32 v10, 192, v7
    v_and_b32 v249, 1, v244
    v_lshlrev_b32 v249, 3, v249
    v_lshl_add_u32 v249, v246, 1, v249
    v_lshrrev_b32 v250, 1, v247
    v_xor_b32 v249, v249, v250
    s_lshl_b32 s58, s55, 3
    v_xor_b32 v249, s58, v249
    v_lshlrev_b32 v249, 4, v249
    v_and_b32 v250, 1, v247
    v_lshl_add_u32 v249, v250, 3, v249
    v_lshl_add_u32 v249, v246, 8, v249
    v_lshl_add_u32 v249, v244, 12, v249
    s_add_u32 s59, s59, 49152
    v_add_u32 v11, s59, v249
    v_xor_b32 v12, 32, v11
    v_xor_b32 v13, 64, v11
    v_xor_b32 v14, 96, v11
    v_xor_b32 v15, 2048, v11
    v_xor_b32 v16, 2048, v12
    v_xor_b32 v17, 2048, v13
    v_xor_b32 v18, 2048, v14
    v_and_b32 v249, 1, v244
    v_lshlrev_b32 v249, 3, v249
    v_lshl_add_u32 v249, v246, 1, v249
    v_lshrrev_b32 v250, 1, v247
    v_xor_b32 v249, v249, v250
    s_lshl_b32 s58, s3, 2
    v_xor_b32 v249, s58, v249
    v_lshlrev_b32 v249, 4, v249
    v_and_b32 v250, 1, v247
    v_lshl_add_u32 v249, v250, 3, v249
    v_lshl_add_u32 v250, v244, 2, v246
    v_lshl_add_u32 v249, v250, 8, v249
    v_add_u32 v19, 49152, v249
    v_xor_b32 v20, 32, v19
    s_mul_i32 s58, s3, 10240
    s_add_u32 s58, s58, 114688
    v_add_u32 v6, s58, v21
    s_xor_b32 s58, s3, 1
    s_mul_i32 s58, s58, 10240
    s_add_u32 s58, s58, 114688
    v_add_u32 v5, s58, v21
    v_mov_b32 v249, 0x3f803f80
    v_accvgpr_write_b32 a36, v249
    v_accvgpr_write_b32 a37, v249
    v_accvgpr_write_b32 a38, v249
    v_accvgpr_write_b32 a39, v249
    s_mov_b32 s68, 0x3e0293ee
    s_mov_b32 s69, s68
    s_lshl_b32 s58, s57, 7
    s_add_u32 m0, s62, 73728
    s_lshl_b32 s59, s57, 19
    buffer_load_dwordx4 v24, s[20:23], s58 offen offset:0 lds
    buffer_load_dwordx4 v25, s[20:23], s58 offen offset:1024 lds
    buffer_load_dwordx4 v26, s[20:23], s58 offen offset:2048 lds
    buffer_load_dwordx4 v27, s[20:23], s58 offen offset:3072 lds
    s_add_u32 m0, s62, 77824
    s_add_u32 s57, s57, 1
    buffer_load_dwordx4 v28, s[20:23], s58 offen lds
    s_add_u32 m0, s63, 73728
    s_and_b32 s57, s57, 7
    buffer_load_dwordx4 v29, s[32:35], s59 offen offset:0 nt lds
    buffer_load_dwordx4 v30, s[32:35], s59 offen offset:1024 nt lds
    buffer_load_dwordx4 v31, s[32:35], s59 offen offset:2048 nt lds
    buffer_load_dwordx4 v32, s[32:35], s59 offen offset:3072 nt lds
    s_waitcnt vmcnt(9)
    s_barrier
    ds_read_b64_tr_b16 a[100:101], v37 offset:36864
    ds_read_b64_tr_b16 a[102:103], v37 offset:37888
    ds_read_b128 a[80:83], v33 offset:36864
    ds_read_b128 a[84:87], v33 offset:38912
    ds_read_b128 a[88:91], v33 offset:40960
    ds_read_b128 a[92:95], v33 offset:43008
    ds_read_b128 a[96:99], v33 offset:45056
    ds_read_b64_tr_b16 a[104:105], v37 offset:36872
    ds_read_b64_tr_b16 a[106:107], v37 offset:37896
    ds_read_b64_tr_b16 a[108:109], v38 offset:36864
    ds_read_b64_tr_b16 a[110:111], v38 offset:37888
    ds_read_b64_tr_b16 a[112:113], v38 offset:36872
    ds_read_b64_tr_b16 a[114:115], v38 offset:37896
    s_waitcnt lgkmcnt(0)
    v_mfma_f32_16x16x32_bf16 v[124:127], a[100:103], a[80:83], 0
    s_lshl_b32 s58, s57, 7
    ds_read_b64_tr_b16 a[136:137], v37 offset:45056
    v_mfma_f32_16x16x32_bf16 v[128:131], a[100:103], a[84:87], 0
    s_add_u32 m0, s62, 0
    ds_read_b64_tr_b16 a[138:139], v37 offset:46080
    v_mfma_f32_16x16x32_bf16 v[132:135], a[100:103], a[88:91], 0
    s_lshl_b32 s59, s57, 19
    ds_read_b128 a[116:119], v34 offset:36864
    buffer_load_dwordx4 v24, s[20:23], s58 offen offset:0 lds
    v_mfma_f32_16x16x32_bf16 v[136:139], a[100:103], a[92:95], 0
    ds_read_b128 a[120:123], v34 offset:38912
    buffer_load_dwordx4 v25, s[20:23], s58 offen offset:1024 lds
    v_mfma_f32_16x16x32_bf16 v[140:143], a[100:103], a[96:99], 0
    ds_read_b128 a[124:127], v34 offset:40960
    buffer_load_dwordx4 v26, s[20:23], s58 offen offset:2048 lds
    v_mfma_f32_16x16x32_bf16 v[144:147], a[104:107], a[80:83], 0
    ds_read_b128 a[128:131], v34 offset:43008
    buffer_load_dwordx4 v27, s[20:23], s58 offen offset:3072 lds
    v_mfma_f32_16x16x32_bf16 v[148:151], a[104:107], a[84:87], 0
    s_add_u32 m0, s62, 4096
    ds_read_b128 a[132:135], v34 offset:45056
    v_mfma_f32_16x16x32_bf16 v[152:155], a[104:107], a[88:91], 0
    s_add_u32 s57, s57, 1
    ds_read_b64_tr_b16 a[140:141], v37 offset:45064
    buffer_load_dwordx4 v28, s[20:23], s58 offen lds
    v_mfma_f32_16x16x32_bf16 v[156:159], a[104:107], a[92:95], 0
    s_add_u32 m0, s63, 0
    ds_read_b64_tr_b16 a[142:143], v37 offset:46088
    v_mfma_f32_16x16x32_bf16 v[160:163], a[104:107], a[96:99], 0
    s_and_b32 s57, s57, 7
    ds_read_b64_tr_b16 a[144:145], v38 offset:45056
    buffer_load_dwordx4 v29, s[32:35], s59 offen offset:0 nt lds
    v_mfma_f32_16x16x32_bf16 v[164:167], a[108:111], a[80:83], 0
    ds_read_b64_tr_b16 a[146:147], v38 offset:46080
    buffer_load_dwordx4 v30, s[32:35], s59 offen offset:1024 nt lds
    v_mfma_f32_16x16x32_bf16 v[168:171], a[108:111], a[84:87], 0
    ds_read_b64_tr_b16 a[148:149], v38 offset:45064
    buffer_load_dwordx4 v31, s[32:35], s59 offen offset:2048 nt lds
    v_mfma_f32_16x16x32_bf16 v[172:175], a[108:111], a[88:91], 0
    ds_read_b64_tr_b16 a[150:151], v38 offset:46088
    buffer_load_dwordx4 v32, s[32:35], s59 offen offset:3072 nt lds
    v_mfma_f32_16x16x32_bf16 v[176:179], a[108:111], a[92:95], 0
    s_add_u32 m0, s61, 0
    v_mfma_f32_16x16x32_bf16 v[180:183], a[108:111], a[96:99], 0
    s_mov_b32 s58, 0
    buffer_load_dwordx4 v2, s[24:27], s58 offen offset:0 nt lds
    v_mfma_f32_16x16x32_bf16 v[184:187], a[112:115], a[80:83], 0
    buffer_load_dwordx4 v2, s[24:27], s58 offen offset:1024 nt lds
    v_mfma_f32_16x16x32_bf16 v[188:191], a[112:115], a[84:87], 0
    buffer_load_dwordx4 v2, s[24:27], s58 offen offset:2048 nt lds
    v_mfma_f32_16x16x32_bf16 v[192:195], a[112:115], a[88:91], 0
    buffer_load_dwordx4 v2, s[24:27], s58 offen offset:3072 nt lds
    v_mfma_f32_16x16x32_bf16 v[196:199], a[112:115], a[92:95], 0
    v_mfma_f32_16x16x32_bf16 v[200:203], a[112:115], a[96:99], 0
    s_waitcnt vmcnt(13) lgkmcnt(0)
    s_barrier
    v_mfma_f32_16x16x32_bf16 v[124:127], a[136:139], a[116:119], v[124:127]
    s_lshl_b32 s58, s57, 7
    ds_read_b64_tr_b16 a[100:101], v39 offset:0
    v_mfma_f32_16x16x32_bf16 v[128:131], a[136:139], a[120:123], v[128:131]
    s_add_u32 m0, s62, 36864
    ds_read_b64_tr_b16 a[102:103], v39 offset:1024
    v_mfma_f32_16x16x32_bf16 v[132:135], a[136:139], a[124:127], v[132:135]
    s_lshl_b32 s59, s57, 19
    ds_read_b128 a[80:83], v35 offset:0
    buffer_load_dwordx4 v24, s[20:23], s58 offen offset:0 lds
    v_mfma_f32_16x16x32_bf16 v[136:139], a[136:139], a[128:131], v[136:139]
    ds_read_b128 a[84:87], v35 offset:2048
    v_mfma_f32_16x16x32_bf16 v[140:143], a[136:139], a[132:135], v[140:143]
    ds_read_b128 a[88:91], v35 offset:4096
    v_mfma_f32_16x16x32_bf16 v[144:147], a[140:143], a[116:119], v[144:147]
    ds_read_b128 a[92:95], v35 offset:6144
    buffer_load_dwordx4 v25, s[20:23], s58 offen offset:1024 lds
    v_mfma_f32_16x16x32_bf16 v[148:151], a[140:143], a[120:123], v[148:151]
    ds_read_b128 a[96:99], v35 offset:8192
    v_mfma_f32_16x16x32_bf16 v[152:155], a[140:143], a[124:127], v[152:155]
    ds_read_b64_tr_b16 a[104:105], v39 offset:8
    v_mfma_f32_16x16x32_bf16 v[156:159], a[140:143], a[128:131], v[156:159]
    ds_read_b64_tr_b16 a[106:107], v39 offset:1032
    buffer_load_dwordx4 v26, s[20:23], s58 offen offset:2048 lds
    v_mfma_f32_16x16x32_bf16 v[160:163], a[140:143], a[132:135], v[160:163]
    ds_read_b64_tr_b16 a[108:109], v40 offset:0
    v_mfma_f32_16x16x32_bf16 v[164:167], a[144:147], a[116:119], v[164:167]
    ds_read_b64_tr_b16 a[110:111], v40 offset:1024
    v_mfma_f32_16x16x32_bf16 v[168:171], a[144:147], a[120:123], v[168:171]
    ds_read_b64_tr_b16 a[112:113], v40 offset:8
    buffer_load_dwordx4 v27, s[20:23], s58 offen offset:3072 lds
    v_mfma_f32_16x16x32_bf16 v[172:175], a[144:147], a[124:127], v[172:175]
    s_add_u32 m0, s62, 40960
    ds_read_b64_tr_b16 a[114:115], v40 offset:1032
    v_mfma_f32_16x16x32_bf16 v[176:179], a[144:147], a[128:131], v[176:179]
    s_add_u32 s57, s57, 1
    v_mfma_f32_16x16x32_bf16 v[180:183], a[144:147], a[132:135], v[180:183]
    buffer_load_dwordx4 v28, s[20:23], s58 offen lds
    v_mfma_f32_16x16x32_bf16 v[184:187], a[148:151], a[116:119], v[184:187]
    s_add_u32 m0, s63, 36864
    v_mfma_f32_16x16x32_bf16 v[188:191], a[148:151], a[120:123], v[188:191]
    s_and_b32 s57, s57, 7
    v_mfma_f32_16x16x32_bf16 v[192:195], a[148:151], a[124:127], v[192:195]
    buffer_load_dwordx4 v29, s[32:35], s59 offen offset:0 lds
    v_mfma_f32_16x16x32_bf16 v[196:199], a[148:151], a[128:131], v[196:199]
    v_mfma_f32_16x16x32_bf16 v[200:203], a[148:151], a[132:135], v[200:203]
    s_waitcnt lgkmcnt(0)
    v_mfma_f32_16x16x32_bf16 v[124:127], a[100:103], a[80:83], v[124:127]
    ds_read_b64_tr_b16 a[136:137], v39 offset:8192
    buffer_load_dwordx4 v30, s[32:35], s59 offen offset:1024 lds
    v_mfma_f32_16x16x32_bf16 v[128:131], a[100:103], a[84:87], v[128:131]
    ds_read_b64_tr_b16 a[138:139], v39 offset:9216
    v_mfma_f32_16x16x32_bf16 v[132:135], a[100:103], a[88:91], v[132:135]
    ds_read_b128 a[116:119], v36 offset:0
    v_mfma_f32_16x16x32_bf16 v[136:139], a[100:103], a[92:95], v[136:139]
    ds_read_b128 a[120:123], v36 offset:2048
    buffer_load_dwordx4 v31, s[32:35], s59 offen offset:2048 lds
    v_mfma_f32_16x16x32_bf16 v[140:143], a[100:103], a[96:99], v[140:143]
    ds_read_b128 a[124:127], v36 offset:4096
    v_mfma_f32_16x16x32_bf16 v[144:147], a[104:107], a[80:83], v[144:147]
    ds_read_b128 a[128:131], v36 offset:6144
    v_mfma_f32_16x16x32_bf16 v[148:151], a[104:107], a[84:87], v[148:151]
    ds_read_b128 a[132:135], v36 offset:8192
    buffer_load_dwordx4 v32, s[32:35], s59 offen offset:3072 lds
    v_mfma_f32_16x16x32_bf16 v[152:155], a[104:107], a[88:91], v[152:155]
    ds_read_b64_tr_b16 a[140:141], v39 offset:8200
    v_and_b32 v249, 31, v1
    v_mfma_f32_16x16x32_bf16 v[156:159], a[104:107], a[92:95], v[156:159]
    ds_read_b64_tr_b16 a[142:143], v39 offset:9224
    v_lshrrev_b32 v250, 1, v249
    v_mfma_f32_16x16x32_bf16 v[160:163], a[104:107], a[96:99], v[160:163]
    ds_read_b64_tr_b16 a[144:145], v40 offset:8192
    v_and_b32 v249, 1, v249
    v_mfma_f32_16x16x32_bf16 v[164:167], a[108:111], a[80:83], v[164:167]
    ds_read_b64_tr_b16 a[146:147], v40 offset:9216
    v_lshlrev_b32 v249, 7, v249
    v_mfma_f32_16x16x32_bf16 v[168:171], a[108:111], a[84:87], v[168:171]
    ds_read_b64_tr_b16 a[148:149], v40 offset:8200
    v_lshl_add_u32 v249, v250, 10, v249
    v_mfma_f32_16x16x32_bf16 v[172:175], a[108:111], a[88:91], v[172:175]
    s_lshl_b32 s65, s53, 16
    ds_read_b64_tr_b16 a[150:151], v40 offset:9224
    buffer_load_dword v253, v249, s[36:39], s65 offen nt
    v_mfma_f32_16x16x32_bf16 v[176:179], a[108:111], a[92:95], v[176:179]
    v_mfma_f32_16x16x32_bf16 v[180:183], a[108:111], a[96:99], v[180:183]
    v_mfma_f32_16x16x32_bf16 v[184:187], a[112:115], a[80:83], v[184:187]
    v_mfma_f32_16x16x32_bf16 v[188:191], a[112:115], a[84:87], v[188:191]
    v_mfma_f32_16x16x32_bf16 v[192:195], a[112:115], a[88:91], v[192:195]
    v_mfma_f32_16x16x32_bf16 v[196:199], a[112:115], a[92:95], v[196:199]
    v_mfma_f32_16x16x32_bf16 v[200:203], a[112:115], a[96:99], v[200:203]
    s_waitcnt vmcnt(14) lgkmcnt(0)
    s_barrier
    v_mfma_f32_16x16x32_bf16 v[124:127], a[136:139], a[116:119], v[124:127]
    s_lshl_b32 s58, s57, 7
    ds_read_b64_tr_b16 a[100:101], v37 offset:0
    v_mfma_f32_16x16x32_bf16 v[128:131], a[136:139], a[120:123], v[128:131]
    s_add_u32 m0, s62, 73728
    ds_read_b64_tr_b16 a[102:103], v37 offset:1024
    v_mfma_f32_16x16x32_bf16 v[132:135], a[136:139], a[124:127], v[132:135]
    s_lshl_b32 s59, s57, 19
    ds_read_b128 a[80:83], v33 offset:0
    buffer_load_dwordx4 v24, s[20:23], s58 offen offset:0 lds
    v_mfma_f32_16x16x32_bf16 v[136:139], a[136:139], a[128:131], v[136:139]
    ds_read_b128 a[84:87], v33 offset:2048
    v_mfma_f32_16x16x32_bf16 v[140:143], a[136:139], a[132:135], v[140:143]
    ds_read_b128 a[88:91], v33 offset:4096
    v_mfma_f32_16x16x32_bf16 v[144:147], a[140:143], a[116:119], v[144:147]
    ds_read_b128 a[92:95], v33 offset:6144
    buffer_load_dwordx4 v25, s[20:23], s58 offen offset:1024 lds
    v_mfma_f32_16x16x32_bf16 v[148:151], a[140:143], a[120:123], v[148:151]
    ds_read_b128 a[96:99], v33 offset:8192
    v_mfma_f32_16x16x32_bf16 v[152:155], a[140:143], a[124:127], v[152:155]
    ds_read_b64_tr_b16 a[104:105], v37 offset:8
    v_mfma_f32_16x16x32_bf16 v[156:159], a[140:143], a[128:131], v[156:159]
    ds_read_b64_tr_b16 a[106:107], v37 offset:1032
    buffer_load_dwordx4 v26, s[20:23], s58 offen offset:2048 lds
    v_mfma_f32_16x16x32_bf16 v[160:163], a[140:143], a[132:135], v[160:163]
    ds_read_b64_tr_b16 a[108:109], v38 offset:0
    v_mfma_f32_16x16x32_bf16 v[164:167], a[144:147], a[116:119], v[164:167]
    ds_read_b64_tr_b16 a[110:111], v38 offset:1024
    v_mfma_f32_16x16x32_bf16 v[168:171], a[144:147], a[120:123], v[168:171]
    ds_read_b64_tr_b16 a[112:113], v38 offset:8
    buffer_load_dwordx4 v27, s[20:23], s58 offen offset:3072 lds
    v_mfma_f32_16x16x32_bf16 v[172:175], a[144:147], a[124:127], v[172:175]
    s_add_u32 m0, s62, 77824
    ds_read_b64_tr_b16 a[114:115], v38 offset:1032
    v_mfma_f32_16x16x32_bf16 v[176:179], a[144:147], a[128:131], v[176:179]
    s_add_u32 s57, s57, 1
    v_mfma_f32_16x16x32_bf16 v[180:183], a[144:147], a[132:135], v[180:183]
    buffer_load_dwordx4 v28, s[20:23], s58 offen lds
    v_mfma_f32_16x16x32_bf16 v[184:187], a[148:151], a[116:119], v[184:187]
    s_add_u32 m0, s63, 73728
    v_mfma_f32_16x16x32_bf16 v[188:191], a[148:151], a[120:123], v[188:191]
    s_and_b32 s57, s57, 7
    v_mfma_f32_16x16x32_bf16 v[192:195], a[148:151], a[124:127], v[192:195]
    buffer_load_dwordx4 v29, s[32:35], s59 offen offset:0 lds
    v_mfma_f32_16x16x32_bf16 v[196:199], a[148:151], a[128:131], v[196:199]
    v_mfma_f32_16x16x32_bf16 v[200:203], a[148:151], a[132:135], v[200:203]
    s_waitcnt lgkmcnt(0)
    v_mfma_f32_16x16x32_bf16 v[124:127], a[100:103], a[80:83], v[124:127]
    ds_read_b64_tr_b16 a[136:137], v37 offset:8192
    buffer_load_dwordx4 v30, s[32:35], s59 offen offset:1024 lds
    v_mfma_f32_16x16x32_bf16 v[128:131], a[100:103], a[84:87], v[128:131]
    ds_read_b64_tr_b16 a[138:139], v37 offset:9216
    v_mfma_f32_16x16x32_bf16 v[132:135], a[100:103], a[88:91], v[132:135]
    ds_read_b128 a[116:119], v34 offset:0
    v_mfma_f32_16x16x32_bf16 v[136:139], a[100:103], a[92:95], v[136:139]
    ds_read_b128 a[120:123], v34 offset:2048
    buffer_load_dwordx4 v31, s[32:35], s59 offen offset:2048 lds
    v_mfma_f32_16x16x32_bf16 v[140:143], a[100:103], a[96:99], v[140:143]
    ds_read_b128 a[124:127], v34 offset:4096
    v_mfma_f32_16x16x32_bf16 v[144:147], a[104:107], a[80:83], v[144:147]
    ds_read_b128 a[128:131], v34 offset:6144
    v_mfma_f32_16x16x32_bf16 v[148:151], a[104:107], a[84:87], v[148:151]
    ds_read_b128 a[132:135], v34 offset:8192
    buffer_load_dwordx4 v32, s[32:35], s59 offen offset:3072 lds
    v_mfma_f32_16x16x32_bf16 v[152:155], a[104:107], a[88:91], v[152:155]
    ds_read_b64_tr_b16 a[140:141], v37 offset:8200
    v_mfma_f32_16x16x32_bf16 v[156:159], a[104:107], a[92:95], v[156:159]
    ds_read_b64_tr_b16 a[142:143], v37 offset:9224
    v_mfma_f32_16x16x32_bf16 v[160:163], a[104:107], a[96:99], v[160:163]
    ds_read_b64_tr_b16 a[144:145], v38 offset:8192
    buffer_store_dwordx2 v[22:23], v41, s[44:47], 0 offen sc1
    v_mfma_f32_16x16x32_bf16 v[164:167], a[108:111], a[80:83], v[164:167]
    ds_read_b64_tr_b16 a[146:147], v38 offset:9216
    v_mfma_f32_16x16x32_bf16 v[168:171], a[108:111], a[84:87], v[168:171]
    ds_read_b64_tr_b16 a[148:149], v38 offset:8200
    v_mfma_f32_16x16x32_bf16 v[172:175], a[108:111], a[88:91], v[172:175]
    ds_read_b64_tr_b16 a[150:151], v38 offset:9224
    v_mfma_f32_16x16x32_bf16 v[176:179], a[108:111], a[92:95], v[176:179]
    v_mfma_f32_16x16x32_bf16 v[180:183], a[108:111], a[96:99], v[180:183]
    v_mfma_f32_16x16x32_bf16 v[184:187], a[112:115], a[80:83], v[184:187]
    v_mfma_f32_16x16x32_bf16 v[188:191], a[112:115], a[84:87], v[188:191]
    v_mfma_f32_16x16x32_bf16 v[192:195], a[112:115], a[88:91], v[192:195]
    v_mfma_f32_16x16x32_bf16 v[196:199], a[112:115], a[92:95], v[196:199]
    v_mfma_f32_16x16x32_bf16 v[200:203], a[112:115], a[96:99], v[200:203]
    s_waitcnt vmcnt(11) lgkmcnt(0)
    s_barrier
    v_mfma_f32_16x16x32_bf16 v[124:127], a[136:139], a[116:119], v[124:127]
    s_lshl_b32 s58, s57, 7
    ds_read_b64_tr_b16 a[100:101], v37 offset:36864
    v_mfma_f32_16x16x32_bf16 v[128:131], a[136:139], a[120:123], v[128:131]
    s_add_u32 m0, s62, 0
    ds_read_b64_tr_b16 a[102:103], v37 offset:37888
    v_mfma_f32_16x16x32_bf16 v[132:135], a[136:139], a[124:127], v[132:135]
    s_lshl_b32 s59, s57, 19
    ds_read_b128 a[80:83], v33 offset:36864
    buffer_load_dwordx4 v24, s[20:23], s58 offen offset:0 lds
    v_mfma_f32_16x16x32_bf16 v[136:139], a[136:139], a[128:131], v[136:139]
    ds_read_b128 a[84:87], v33 offset:38912
    v_mfma_f32_16x16x32_bf16 v[140:143], a[136:139], a[132:135], v[140:143]
    ds_read_b128 a[88:91], v33 offset:40960
    v_mfma_f32_16x16x32_bf16 v[144:147], a[140:143], a[116:119], v[144:147]
    ds_read_b128 a[92:95], v33 offset:43008
    buffer_load_dwordx4 v25, s[20:23], s58 offen offset:1024 lds
    v_mfma_f32_16x16x32_bf16 v[148:151], a[140:143], a[120:123], v[148:151]
    ds_read_b128 a[96:99], v33 offset:45056
    v_mfma_f32_16x16x32_bf16 v[152:155], a[140:143], a[124:127], v[152:155]
    ds_read_b64_tr_b16 a[104:105], v37 offset:36872
    v_mfma_f32_16x16x32_bf16 v[156:159], a[140:143], a[128:131], v[156:159]
    ds_read_b64_tr_b16 a[106:107], v37 offset:37896
    buffer_load_dwordx4 v26, s[20:23], s58 offen offset:2048 lds
    v_mfma_f32_16x16x32_bf16 v[160:163], a[140:143], a[132:135], v[160:163]
    ds_read_b64_tr_b16 a[108:109], v38 offset:36864
    v_mfma_f32_16x16x32_bf16 v[164:167], a[144:147], a[116:119], v[164:167]
    ds_read_b64_tr_b16 a[110:111], v38 offset:37888
    v_mfma_f32_16x16x32_bf16 v[168:171], a[144:147], a[120:123], v[168:171]
    ds_read_b64_tr_b16 a[112:113], v38 offset:36872
    buffer_load_dwordx4 v27, s[20:23], s58 offen offset:3072 lds
    v_mfma_f32_16x16x32_bf16 v[172:175], a[144:147], a[124:127], v[172:175]
    s_add_u32 m0, s62, 4096
    ds_read_b64_tr_b16 a[114:115], v38 offset:37896
    v_mfma_f32_16x16x32_bf16 v[176:179], a[144:147], a[128:131], v[176:179]
    s_add_u32 s57, s57, 1
    v_mfma_f32_16x16x32_bf16 v[180:183], a[144:147], a[132:135], v[180:183]
    buffer_load_dwordx4 v28, s[20:23], s58 offen lds
    v_mfma_f32_16x16x32_bf16 v[184:187], a[148:151], a[116:119], v[184:187]
    s_add_u32 m0, s63, 0
    v_mfma_f32_16x16x32_bf16 v[188:191], a[148:151], a[120:123], v[188:191]
    s_and_b32 s57, s57, 7
    v_mfma_f32_16x16x32_bf16 v[192:195], a[148:151], a[124:127], v[192:195]
    buffer_load_dwordx4 v29, s[32:35], s59 offen offset:0 lds
    v_mfma_f32_16x16x32_bf16 v[196:199], a[148:151], a[128:131], v[196:199]
    v_mfma_f32_16x16x32_bf16 v[200:203], a[148:151], a[132:135], v[200:203]
    s_waitcnt lgkmcnt(0)
    v_mfma_f32_16x16x32_bf16 v[124:127], a[100:103], a[80:83], v[124:127]
    ds_read_b64_tr_b16 a[136:137], v37 offset:45056
    buffer_load_dwordx4 v30, s[32:35], s59 offen offset:1024 lds
    v_mfma_f32_16x16x32_bf16 v[128:131], a[100:103], a[84:87], v[128:131]
    ds_read_b64_tr_b16 a[138:139], v37 offset:46080
    v_mfma_f32_16x16x32_bf16 v[132:135], a[100:103], a[88:91], v[132:135]
    ds_read_b128 a[116:119], v34 offset:36864
    v_mfma_f32_16x16x32_bf16 v[136:139], a[100:103], a[92:95], v[136:139]
    ds_read_b128 a[120:123], v34 offset:38912
    buffer_load_dwordx4 v31, s[32:35], s59 offen offset:2048 lds
    v_mfma_f32_16x16x32_bf16 v[140:143], a[100:103], a[96:99], v[140:143]
    ds_read_b128 a[124:127], v34 offset:40960
    v_mfma_f32_16x16x32_bf16 v[144:147], a[104:107], a[80:83], v[144:147]
    ds_read_b128 a[128:131], v34 offset:43008
    v_mfma_f32_16x16x32_bf16 v[148:151], a[104:107], a[84:87], v[148:151]
    ds_read_b128 a[132:135], v34 offset:45056
    buffer_load_dwordx4 v32, s[32:35], s59 offen offset:3072 lds
    v_mfma_f32_16x16x32_bf16 v[152:155], a[104:107], a[88:91], v[152:155]
    ds_read_b64_tr_b16 a[140:141], v37 offset:45064
    v_mfma_f32_16x16x32_bf16 v[156:159], a[104:107], a[92:95], v[156:159]
    ds_read_b64_tr_b16 a[142:143], v37 offset:46088
    v_mfma_f32_16x16x32_bf16 v[160:163], a[104:107], a[96:99], v[160:163]
    ds_read_b64_tr_b16 a[144:145], v38 offset:45056
    v_mfma_f32_16x16x32_bf16 v[164:167], a[108:111], a[80:83], v[164:167]
    ds_read_b64_tr_b16 a[146:147], v38 offset:46080
    v_mfma_f32_16x16x32_bf16 v[168:171], a[108:111], a[84:87], v[168:171]
    ds_read_b64_tr_b16 a[148:149], v38 offset:45064
    v_mfma_f32_16x16x32_bf16 v[172:175], a[108:111], a[88:91], v[172:175]
    ds_read_b64_tr_b16 a[150:151], v38 offset:46088
    v_mfma_f32_16x16x32_bf16 v[176:179], a[108:111], a[92:95], v[176:179]
    v_mfma_f32_16x16x32_bf16 v[180:183], a[108:111], a[96:99], v[180:183]
    v_mfma_f32_16x16x32_bf16 v[184:187], a[112:115], a[80:83], v[184:187]
    v_mfma_f32_16x16x32_bf16 v[188:191], a[112:115], a[84:87], v[188:191]
    v_mfma_f32_16x16x32_bf16 v[192:195], a[112:115], a[88:91], v[192:195]
    v_mfma_f32_16x16x32_bf16 v[196:199], a[112:115], a[92:95], v[196:199]
    v_mfma_f32_16x16x32_bf16 v[200:203], a[112:115], a[96:99], v[200:203]
    s_waitcnt vmcnt(10) lgkmcnt(0)
    s_barrier
    v_mfma_f32_16x16x32_bf16 v[124:127], a[136:139], a[116:119], v[124:127]
    s_lshl_b32 s58, s57, 7
    ds_read_b64_tr_b16 a[100:101], v39 offset:0
    v_mfma_f32_16x16x32_bf16 v[128:131], a[136:139], a[120:123], v[128:131]
    s_add_u32 m0, s62, 36864
    ds_read_b64_tr_b16 a[102:103], v39 offset:1024
    v_mfma_f32_16x16x32_bf16 v[132:135], a[136:139], a[124:127], v[132:135]
    s_lshl_b32 s59, s57, 19
    ds_read_b128 a[80:83], v35 offset:0
    buffer_load_dwordx4 v24, s[20:23], s58 offen offset:0 lds
    v_mfma_f32_16x16x32_bf16 v[136:139], a[136:139], a[128:131], v[136:139]
    ds_read_b128 a[84:87], v35 offset:2048
    v_mfma_f32_16x16x32_bf16 v[140:143], a[136:139], a[132:135], v[140:143]
    ds_read_b128 a[88:91], v35 offset:4096
    v_mfma_f32_16x16x32_bf16 v[144:147], a[140:143], a[116:119], v[144:147]
    ds_read_b128 a[92:95], v35 offset:6144
    buffer_load_dwordx4 v25, s[20:23], s58 offen offset:1024 lds
    v_mfma_f32_16x16x32_bf16 v[148:151], a[140:143], a[120:123], v[148:151]
    ds_read_b128 a[96:99], v35 offset:8192
    v_mfma_f32_16x16x32_bf16 v[152:155], a[140:143], a[124:127], v[152:155]
    ds_read_b64_tr_b16 a[104:105], v39 offset:8
    v_mfma_f32_16x16x32_bf16 v[156:159], a[140:143], a[128:131], v[156:159]
    ds_read_b64_tr_b16 a[106:107], v39 offset:1032
    buffer_load_dwordx4 v26, s[20:23], s58 offen offset:2048 lds
    v_mfma_f32_16x16x32_bf16 v[160:163], a[140:143], a[132:135], v[160:163]
    ds_read_b64_tr_b16 a[108:109], v40 offset:0
    v_mfma_f32_16x16x32_bf16 v[164:167], a[144:147], a[116:119], v[164:167]
    ds_read_b64_tr_b16 a[110:111], v40 offset:1024
    v_mfma_f32_16x16x32_bf16 v[168:171], a[144:147], a[120:123], v[168:171]
    ds_read_b64_tr_b16 a[112:113], v40 offset:8
    buffer_load_dwordx4 v27, s[20:23], s58 offen offset:3072 lds
    v_mfma_f32_16x16x32_bf16 v[172:175], a[144:147], a[124:127], v[172:175]
    s_add_u32 m0, s62, 40960
    ds_read_b64_tr_b16 a[114:115], v40 offset:1032
    v_mfma_f32_16x16x32_bf16 v[176:179], a[144:147], a[128:131], v[176:179]
    s_add_u32 s57, s57, 1
    v_mfma_f32_16x16x32_bf16 v[180:183], a[144:147], a[132:135], v[180:183]
    buffer_load_dwordx4 v28, s[20:23], s58 offen lds
    v_mfma_f32_16x16x32_bf16 v[184:187], a[148:151], a[116:119], v[184:187]
    s_add_u32 m0, s63, 36864
    v_mfma_f32_16x16x32_bf16 v[188:191], a[148:151], a[120:123], v[188:191]
    s_and_b32 s57, s57, 7
    v_mfma_f32_16x16x32_bf16 v[192:195], a[148:151], a[124:127], v[192:195]
    buffer_load_dwordx4 v29, s[32:35], s59 offen offset:0 lds
    v_mfma_f32_16x16x32_bf16 v[196:199], a[148:151], a[128:131], v[196:199]
    v_mfma_f32_16x16x32_bf16 v[200:203], a[148:151], a[132:135], v[200:203]
    s_waitcnt lgkmcnt(0)
    v_mfma_f32_16x16x32_bf16 v[124:127], a[100:103], a[80:83], v[124:127]
    ds_read_b64_tr_b16 a[136:137], v39 offset:8192
    buffer_load_dwordx4 v30, s[32:35], s59 offen offset:1024 lds
    v_mfma_f32_16x16x32_bf16 v[128:131], a[100:103], a[84:87], v[128:131]
    ds_read_b64_tr_b16 a[138:139], v39 offset:9216
    v_mfma_f32_16x16x32_bf16 v[132:135], a[100:103], a[88:91], v[132:135]
    ds_read_b128 a[116:119], v36 offset:0
    v_mfma_f32_16x16x32_bf16 v[136:139], a[100:103], a[92:95], v[136:139]
    ds_read_b128 a[120:123], v36 offset:2048
    buffer_load_dwordx4 v31, s[32:35], s59 offen offset:2048 lds
    v_mfma_f32_16x16x32_bf16 v[140:143], a[100:103], a[96:99], v[140:143]
    ds_read_b128 a[124:127], v36 offset:4096
    v_mfma_f32_16x16x32_bf16 v[144:147], a[104:107], a[80:83], v[144:147]
    ds_read_b128 a[128:131], v36 offset:6144
    v_mfma_f32_16x16x32_bf16 v[148:151], a[104:107], a[84:87], v[148:151]
    ds_read_b128 a[132:135], v36 offset:8192
    buffer_load_dwordx4 v32, s[32:35], s59 offen offset:3072 lds
    v_mfma_f32_16x16x32_bf16 v[152:155], a[104:107], a[88:91], v[152:155]
    ds_read_b64_tr_b16 a[140:141], v39 offset:8200
    v_mfma_f32_16x16x32_bf16 v[156:159], a[104:107], a[92:95], v[156:159]
    ds_read_b64_tr_b16 a[142:143], v39 offset:9224
    v_mfma_f32_16x16x32_bf16 v[160:163], a[104:107], a[96:99], v[160:163]
    ds_read_b64_tr_b16 a[144:145], v40 offset:8192
    buffer_load_dword v252, v249, s[36:39], s65 offen
    v_mfma_f32_16x16x32_bf16 v[164:167], a[108:111], a[80:83], v[164:167]
    ds_read_b64_tr_b16 a[146:147], v40 offset:9216
    v_mfma_f32_16x16x32_bf16 v[168:171], a[108:111], a[84:87], v[168:171]
    ds_read_b64_tr_b16 a[148:149], v40 offset:8200
    v_mfma_f32_16x16x32_bf16 v[172:175], a[108:111], a[88:91], v[172:175]
    ds_read_b64_tr_b16 a[150:151], v40 offset:9224
    v_mfma_f32_16x16x32_bf16 v[176:179], a[108:111], a[92:95], v[176:179]
    v_mfma_f32_16x16x32_bf16 v[180:183], a[108:111], a[96:99], v[180:183]
    v_mfma_f32_16x16x32_bf16 v[184:187], a[112:115], a[80:83], v[184:187]
    v_mfma_f32_16x16x32_bf16 v[188:191], a[112:115], a[84:87], v[188:191]
    v_mfma_f32_16x16x32_bf16 v[192:195], a[112:115], a[88:91], v[192:195]
    v_mfma_f32_16x16x32_bf16 v[196:199], a[112:115], a[92:95], v[196:199]
    v_mfma_f32_16x16x32_bf16 v[200:203], a[112:115], a[96:99], v[200:203]
    s_waitcnt vmcnt(10) lgkmcnt(0)
    s_barrier
    v_mfma_f32_16x16x32_bf16 v[124:127], a[136:139], a[116:119], v[124:127]
    s_lshl_b32 s58, s57, 7
    ds_read_b64_tr_b16 a[100:101], v37 offset:0
    v_mfma_f32_16x16x32_bf16 v[128:131], a[136:139], a[120:123], v[128:131]
    s_add_u32 m0, s62, 73728
    ds_read_b64_tr_b16 a[102:103], v37 offset:1024
    v_mfma_f32_16x16x32_bf16 v[132:135], a[136:139], a[124:127], v[132:135]
    s_lshl_b32 s59, s57, 19
    ds_read_b128 a[80:83], v33 offset:0
    buffer_load_dwordx4 v24, s[20:23], s58 offen offset:0 lds
    v_mfma_f32_16x16x32_bf16 v[136:139], a[136:139], a[128:131], v[136:139]
    ds_read_b128 a[84:87], v33 offset:2048
    v_mfma_f32_16x16x32_bf16 v[140:143], a[136:139], a[132:135], v[140:143]
    ds_read_b128 a[88:91], v33 offset:4096
    v_mfma_f32_16x16x32_bf16 v[144:147], a[140:143], a[116:119], v[144:147]
    ds_read_b128 a[92:95], v33 offset:6144
    buffer_load_dwordx4 v25, s[20:23], s58 offen offset:1024 lds
    v_mfma_f32_16x16x32_bf16 v[148:151], a[140:143], a[120:123], v[148:151]
    ds_read_b128 a[96:99], v33 offset:8192
    v_mfma_f32_16x16x32_bf16 v[152:155], a[140:143], a[124:127], v[152:155]
    ds_read_b64_tr_b16 a[104:105], v37 offset:8
    v_mfma_f32_16x16x32_bf16 v[156:159], a[140:143], a[128:131], v[156:159]
    ds_read_b64_tr_b16 a[106:107], v37 offset:1032
    buffer_load_dwordx4 v26, s[20:23], s58 offen offset:2048 lds
    v_mfma_f32_16x16x32_bf16 v[160:163], a[140:143], a[132:135], v[160:163]
    ds_read_b64_tr_b16 a[108:109], v38 offset:0
    v_mfma_f32_16x16x32_bf16 v[164:167], a[144:147], a[116:119], v[164:167]
    ds_read_b64_tr_b16 a[110:111], v38 offset:1024
    v_mfma_f32_16x16x32_bf16 v[168:171], a[144:147], a[120:123], v[168:171]
    ds_read_b64_tr_b16 a[112:113], v38 offset:8
    buffer_load_dwordx4 v27, s[20:23], s58 offen offset:3072 lds
    v_mfma_f32_16x16x32_bf16 v[172:175], a[144:147], a[124:127], v[172:175]
    s_add_u32 m0, s62, 77824
    ds_read_b64_tr_b16 a[114:115], v38 offset:1032
    v_mfma_f32_16x16x32_bf16 v[176:179], a[144:147], a[128:131], v[176:179]
    s_add_u32 s57, s57, 1
    v_mfma_f32_16x16x32_bf16 v[180:183], a[144:147], a[132:135], v[180:183]
    buffer_load_dwordx4 v28, s[20:23], s58 offen lds
    v_mfma_f32_16x16x32_bf16 v[184:187], a[148:151], a[116:119], v[184:187]
    s_add_u32 m0, s63, 73728
    v_mfma_f32_16x16x32_bf16 v[188:191], a[148:151], a[120:123], v[188:191]
    s_and_b32 s57, s57, 7
    v_mfma_f32_16x16x32_bf16 v[192:195], a[148:151], a[124:127], v[192:195]
    buffer_load_dwordx4 v29, s[32:35], s59 offen offset:0 lds
    v_mfma_f32_16x16x32_bf16 v[196:199], a[148:151], a[128:131], v[196:199]
    v_mfma_f32_16x16x32_bf16 v[200:203], a[148:151], a[132:135], v[200:203]
    s_waitcnt lgkmcnt(0)
    v_mfma_f32_16x16x32_bf16 v[124:127], a[100:103], a[80:83], v[124:127]
    ds_read_b64_tr_b16 a[136:137], v37 offset:8192
    buffer_load_dwordx4 v30, s[32:35], s59 offen offset:1024 lds
    v_mfma_f32_16x16x32_bf16 v[128:131], a[100:103], a[84:87], v[128:131]
    ds_read_b64_tr_b16 a[138:139], v37 offset:9216
    v_mfma_f32_16x16x32_bf16 v[132:135], a[100:103], a[88:91], v[132:135]
    ds_read_b128 a[116:119], v34 offset:0
    v_mfma_f32_16x16x32_bf16 v[136:139], a[100:103], a[92:95], v[136:139]
    ds_read_b128 a[120:123], v34 offset:2048
    buffer_load_dwordx4 v31, s[32:35], s59 offen offset:2048 lds
    v_mfma_f32_16x16x32_bf16 v[140:143], a[100:103], a[96:99], v[140:143]
    ds_read_b128 a[124:127], v34 offset:4096
    v_mfma_f32_16x16x32_bf16 v[144:147], a[104:107], a[80:83], v[144:147]
    ds_read_b128 a[128:131], v34 offset:6144
    v_mfma_f32_16x16x32_bf16 v[148:151], a[104:107], a[84:87], v[148:151]
    ds_read_b128 a[132:135], v34 offset:8192
    buffer_load_dwordx4 v32, s[32:35], s59 offen offset:3072 lds
    v_mfma_f32_16x16x32_bf16 v[152:155], a[104:107], a[88:91], v[152:155]
    s_add_u32 m0, s61, 16384
    ds_read_b64_tr_b16 a[140:141], v37 offset:8200
    v_mfma_f32_16x16x32_bf16 v[156:159], a[104:107], a[92:95], v[156:159]
    s_mov_b32 s58, 16384
    ds_read_b64_tr_b16 a[142:143], v37 offset:9224
    v_mfma_f32_16x16x32_bf16 v[160:163], a[104:107], a[96:99], v[160:163]
    ds_read_b64_tr_b16 a[144:145], v38 offset:8192
    buffer_load_dwordx4 v2, s[24:27], s58 offen offset:0 nt lds
    v_mfma_f32_16x16x32_bf16 v[164:167], a[108:111], a[80:83], v[164:167]
    ds_read_b64_tr_b16 a[146:147], v38 offset:9216
    v_mfma_f32_16x16x32_bf16 v[168:171], a[108:111], a[84:87], v[168:171]
    ds_read_b64_tr_b16 a[148:149], v38 offset:8200
    v_mfma_f32_16x16x32_bf16 v[172:175], a[108:111], a[88:91], v[172:175]
    ds_read_b64_tr_b16 a[150:151], v38 offset:9224
    buffer_load_dwordx4 v2, s[24:27], s58 offen offset:1024 nt lds
    v_mfma_f32_16x16x32_bf16 v[176:179], a[108:111], a[92:95], v[176:179]
    v_mfma_f32_16x16x32_bf16 v[180:183], a[108:111], a[96:99], v[180:183]
    v_mfma_f32_16x16x32_bf16 v[184:187], a[112:115], a[80:83], v[184:187]
    buffer_load_dwordx4 v2, s[24:27], s58 offen offset:2048 nt lds
    v_mfma_f32_16x16x32_bf16 v[188:191], a[112:115], a[84:87], v[188:191]
    v_mfma_f32_16x16x32_bf16 v[192:195], a[112:115], a[88:91], v[192:195]
    v_mfma_f32_16x16x32_bf16 v[196:199], a[112:115], a[92:95], v[196:199]
    buffer_load_dwordx4 v2, s[24:27], s58 offen offset:3072 nt lds
    v_mfma_f32_16x16x32_bf16 v[200:203], a[112:115], a[96:99], v[200:203]
    s_waitcnt vmcnt(14) lgkmcnt(0)
    s_barrier
    v_mfma_f32_16x16x32_bf16 v[124:127], a[136:139], a[116:119], v[124:127]
    ds_read_b64_tr_b16 a[100:101], v37 offset:36864
    v_mfma_f32_16x16x32_bf16 v[128:131], a[136:139], a[120:123], v[128:131]
    ds_read_b64_tr_b16 a[102:103], v37 offset:37888
    v_mfma_f32_16x16x32_bf16 v[132:135], a[136:139], a[124:127], v[132:135]
    ds_read_b128 a[80:83], v33 offset:36864
    v_mfma_f32_16x16x32_bf16 v[136:139], a[136:139], a[128:131], v[136:139]
    ds_read_b128 a[84:87], v33 offset:38912
    v_mfma_f32_16x16x32_bf16 v[140:143], a[136:139], a[132:135], v[140:143]
    ds_read_b128 a[88:91], v33 offset:40960
    v_mfma_f32_16x16x32_bf16 v[144:147], a[140:143], a[116:119], v[144:147]
    ds_read_b128 a[92:95], v33 offset:43008
    v_mfma_f32_16x16x32_bf16 v[148:151], a[140:143], a[120:123], v[148:151]
    ds_read_b128 a[96:99], v33 offset:45056
    v_mfma_f32_16x16x32_bf16 v[152:155], a[140:143], a[124:127], v[152:155]
    ds_read_b64_tr_b16 a[104:105], v37 offset:36872
    v_mfma_f32_16x16x32_bf16 v[156:159], a[140:143], a[128:131], v[156:159]
    s_add_u32 m0, s61, 32768
    ds_read_b64_tr_b16 a[106:107], v37 offset:37896
    v_mfma_f32_16x16x32_bf16 v[160:163], a[140:143], a[132:135], v[160:163]
    s_mov_b32 s58, 32768
    ds_read_b64_tr_b16 a[108:109], v38 offset:36864
    buffer_load_dwordx4 v2, s[24:27], s58 offen offset:0 nt lds
    v_mfma_f32_16x16x32_bf16 v[164:167], a[144:147], a[116:119], v[164:167]
    ds_read_b64_tr_b16 a[110:111], v38 offset:37888
    v_mfma_f32_16x16x32_bf16 v[168:171], a[144:147], a[120:123], v[168:171]
    ds_read_b64_tr_b16 a[112:113], v38 offset:36872
    v_mfma_f32_16x16x32_bf16 v[172:175], a[144:147], a[124:127], v[172:175]
    ds_read_b64_tr_b16 a[114:115], v38 offset:37896
    v_mfma_f32_16x16x32_bf16 v[176:179], a[144:147], a[128:131], v[176:179]
    v_mfma_f32_16x16x32_bf16 v[180:183], a[144:147], a[132:135], v[180:183]
    v_mfma_f32_16x16x32_bf16 v[184:187], a[148:151], a[116:119], v[184:187]
    buffer_load_dwordx4 v2, s[24:27], s58 offen offset:1024 nt lds
    v_mfma_f32_16x16x32_bf16 v[188:191], a[148:151], a[120:123], v[188:191]
    v_mfma_f32_16x16x32_bf16 v[192:195], a[148:151], a[124:127], v[192:195]
    v_mfma_f32_16x16x32_bf16 v[196:199], a[148:151], a[128:131], v[196:199]
    v_mfma_f32_16x16x32_bf16 v[200:203], a[148:151], a[132:135], v[200:203]
    s_waitcnt lgkmcnt(0)
    v_mfma_f32_16x16x32_bf16 v[124:127], a[100:103], a[80:83], v[124:127]
    ds_read_b64_tr_b16 a[136:137], v37 offset:45056
    v_mfma_f32_16x16x32_bf16 v[128:131], a[100:103], a[84:87], v[128:131]
    ds_read_b64_tr_b16 a[138:139], v37 offset:46080
    buffer_load_dwordx4 v2, s[24:27], s58 offen offset:2048 nt lds
    v_mfma_f32_16x16x32_bf16 v[132:135], a[100:103], a[88:91], v[132:135]
    ds_read_b128 a[116:119], v34 offset:36864
    v_mfma_f32_16x16x32_bf16 v[136:139], a[100:103], a[92:95], v[136:139]
    ds_read_b128 a[120:123], v34 offset:38912
    v_mfma_f32_16x16x32_bf16 v[140:143], a[100:103], a[96:99], v[140:143]
    ds_read_b128 a[124:127], v34 offset:40960
    v_mfma_f32_16x16x32_bf16 v[144:147], a[104:107], a[80:83], v[144:147]
    ds_read_b128 a[128:131], v34 offset:43008
    v_mfma_f32_16x16x32_bf16 v[148:151], a[104:107], a[84:87], v[148:151]
    ds_read_b128 a[132:135], v34 offset:45056
    v_mfma_f32_16x16x32_bf16 v[152:155], a[104:107], a[88:91], v[152:155]
    ds_read_b64_tr_b16 a[140:141], v37 offset:45064
    buffer_load_dwordx4 v2, s[24:27], s58 offen offset:3072 nt lds
    v_mfma_f32_16x16x32_bf16 v[156:159], a[104:107], a[92:95], v[156:159]
    ds_read_b64_tr_b16 a[142:143], v37 offset:46088
    v_mfma_f32_16x16x32_bf16 v[160:163], a[104:107], a[96:99], v[160:163]
    ds_read_b64_tr_b16 a[144:145], v38 offset:45056
    v_mfma_f32_16x16x32_bf16 v[164:167], a[108:111], a[80:83], v[164:167]
    ds_read_b64_tr_b16 a[146:147], v38 offset:46080
    v_mfma_f32_16x16x32_bf16 v[168:171], a[108:111], a[84:87], v[168:171]
    ds_read_b64_tr_b16 a[148:149], v38 offset:45064
    v_mfma_f32_16x16x32_bf16 v[172:175], a[108:111], a[88:91], v[172:175]
    ds_read_b64_tr_b16 a[150:151], v38 offset:46088
    v_mfma_f32_16x16x32_bf16 v[176:179], a[108:111], a[92:95], v[176:179]
    v_mfma_f32_16x16x32_bf16 v[180:183], a[108:111], a[96:99], v[180:183]
    v_mfma_f32_16x16x32_bf16 v[184:187], a[112:115], a[80:83], v[184:187]
    v_mfma_f32_16x16x32_bf16 v[188:191], a[112:115], a[84:87], v[188:191]
    v_mfma_f32_16x16x32_bf16 v[192:195], a[112:115], a[88:91], v[192:195]
    v_mfma_f32_16x16x32_bf16 v[196:199], a[112:115], a[92:95], v[196:199]
    v_mfma_f32_16x16x32_bf16 v[200:203], a[112:115], a[96:99], v[200:203]
    s_waitcnt vmcnt(8) lgkmcnt(0)
    s_barrier
    v_mfma_f32_16x16x32_bf16 v[124:127], a[136:139], a[116:119], v[124:127]
    ds_read_b64_tr_b16 a[100:101], v39 offset:0
    ds_read_b64_tr_b16 a[102:103], v39 offset:1024
    v_mfma_f32_16x16x32_bf16 v[128:131], a[136:139], a[120:123], v[128:131]
    ds_read_b128 a[80:83], v35 offset:0
    v_mov_b32 v244, 0
    v_mfma_f32_16x16x32_bf16 v[132:135], a[136:139], a[124:127], v[132:135]
    ds_read_b128 a[84:87], v35 offset:2048
    ds_read_b128 a[88:91], v35 offset:4096
    v_mfma_f32_16x16x32_bf16 v[136:139], a[136:139], a[128:131], v[136:139]
    ds_read_b128 a[92:95], v35 offset:6144
    buffer_load_dwordx2 v[22:23], v244, s[44:47], 0 offen sc1
    v_mfma_f32_16x16x32_bf16 v[140:143], a[136:139], a[132:135], v[140:143]
    s_add_u32 m0, s61, 49152
    ds_read_b128 a[96:99], v35 offset:8192
    ds_read_b64_tr_b16 a[104:105], v39 offset:8
    v_mfma_f32_16x16x32_bf16 v[144:147], a[140:143], a[116:119], v[144:147]
    s_mov_b32 s58, 0
    ds_read_b64_tr_b16 a[106:107], v39 offset:1032
    v_mfma_f32_16x16x32_bf16 v[148:151], a[140:143], a[120:123], v[148:151]
    ds_read_b64_tr_b16 a[108:109], v40 offset:0
    ds_read_b64_tr_b16 a[110:111], v40 offset:1024
    v_mfma_f32_16x16x32_bf16 v[152:155], a[140:143], a[124:127], v[152:155]
    ds_read_b64_tr_b16 a[112:113], v40 offset:8
    buffer_load_dwordx4 v3, s[28:31], s58 offen offset:0 nt lds
    v_mfma_f32_16x16x32_bf16 v[156:159], a[140:143], a[128:131], v[156:159]
    ds_read_b64_tr_b16 a[114:115], v40 offset:1032
    ds_read_b64_tr_b16 a[172:173], v39 offset:8192
    v_mfma_f32_16x16x32_bf16 v[160:163], a[140:143], a[132:135], v[160:163]
    ds_read_b64_tr_b16 a[174:175], v39 offset:9216
    v_mfma_f32_16x16x32_bf16 v[164:167], a[144:147], a[116:119], v[164:167]
    ds_read_b128 a[152:155], v36 offset:0
    ds_read_b128 a[156:159], v36 offset:2048
    v_mfma_f32_16x16x32_bf16 v[168:171], a[144:147], a[120:123], v[168:171]
    ds_read_b128 a[160:163], v36 offset:4096
    buffer_load_dwordx4 v3, s[28:31], s58 offen offset:1024 nt lds
    v_mfma_f32_16x16x32_bf16 v[172:175], a[144:147], a[124:127], v[172:175]
    ds_read_b128 a[164:167], v36 offset:6144
    ds_read_b128 a[168:171], v36 offset:8192
    v_mfma_f32_16x16x32_bf16 v[176:179], a[144:147], a[128:131], v[176:179]
    ds_read_b64_tr_b16 a[176:177], v39 offset:8200
    v_mfma_f32_16x16x32_bf16 v[180:183], a[144:147], a[132:135], v[180:183]
    ds_read_b64_tr_b16 a[178:179], v39 offset:9224
    ds_read_b64_tr_b16 a[180:181], v40 offset:8192
    v_mfma_f32_16x16x32_bf16 v[184:187], a[148:151], a[116:119], v[184:187]
    ds_read_b64_tr_b16 a[182:183], v40 offset:9216
    buffer_load_dwordx4 v3, s[28:31], s58 offen offset:2048 nt lds
    v_mfma_f32_16x16x32_bf16 v[188:191], a[148:151], a[120:123], v[188:191]
    ds_read_b64_tr_b16 a[184:185], v40 offset:8200
    ds_read_b64_tr_b16 a[186:187], v40 offset:9224
    v_mfma_f32_16x16x32_bf16 v[192:195], a[148:151], a[124:127], v[192:195]
    v_mfma_f32_16x16x32_bf16 v[196:199], a[148:151], a[128:131], v[196:199]
    buffer_load_dwordx4 v3, s[28:31], s58 offen offset:3072 nt lds
    v_mfma_f32_16x16x32_bf16 v[200:203], a[148:151], a[132:135], v[200:203]
    s_waitcnt lgkmcnt(0)
    s_barrier
    v_mfma_f32_16x16x32_bf16 v[124:127], a[100:103], a[80:83], v[124:127]
    v_mfma_f32_16x16x32_bf16 v[144:147], a[104:107], a[80:83], v[144:147]
    v_mfma_f32_16x16x32_bf16 v[124:127], a[172:175], a[152:155], v[124:127]
    v_mfma_f32_16x16x32_bf16 v[144:147], a[176:179], a[152:155], v[144:147]
    v_mfma_f32_16x16x32_bf16 v[128:131], a[100:103], a[84:87], v[128:131]
    v_mfma_f32_16x16x32_bf16 v[148:151], a[104:107], a[84:87], v[148:151]
    v_mfma_f32_16x16x32_bf16 v[128:131], a[172:175], a[156:159], v[128:131]
    v_mfma_f32_16x16x32_bf16 v[148:151], a[176:179], a[156:159], v[148:151]
    v_mfma_f32_16x16x32_bf16 v[132:135], a[100:103], a[88:91], v[132:135]
    s_nop 1
    v_mul_f32 v124, s68, v124
    v_mul_f32 v125, s68, v125
    v_mfma_f32_16x16x32_bf16 v[152:155], a[104:107], a[88:91], v[152:155]
    v_mul_f32 v126, s68, v126
    v_mul_f32 v127, s68, v127
    v_mfma_f32_16x16x32_bf16 v[132:135], a[172:175], a[160:163], v[132:135]
    v_cvt_pk_bf16_f32 v84, v124, v125
    v_cvt_pk_bf16_f32 v85, v126, v127
    v_mfma_f32_16x16x32_bf16 v[152:155], a[176:179], a[160:163], v[152:155]
    v_mul_f32 v144, s68, v144
    v_mul_f32 v145, s68, v145
    v_mfma_f32_16x16x32_bf16 v[136:139], a[100:103], a[92:95], v[136:139]
    v_mul_f32 v146, s68, v146
    v_mul_f32 v147, s68, v147
    v_mfma_f32_16x16x32_bf16 v[156:159], a[104:107], a[92:95], v[156:159]
    v_cvt_pk_bf16_f32 v86, v144, v145
    v_cvt_pk_bf16_f32 v87, v146, v147
    v_mfma_f32_16x16x32_bf16 v[136:139], a[172:175], a[164:167], v[136:139]
    ds_write_b128 v6, v[84:87] offset:0
    v_mfma_f32_16x16x32_bf16 v[156:159], a[176:179], a[164:167], v[156:159]
    v_mul_f32 v128, s68, v128
    v_mul_f32 v129, s68, v129
    v_mfma_f32_16x16x32_bf16 v[140:143], a[100:103], a[96:99], v[140:143]
    v_mul_f32 v130, s68, v130
    v_mul_f32 v131, s68, v131
    v_mfma_f32_16x16x32_bf16 v[160:163], a[104:107], a[96:99], v[160:163]
    v_cvt_pk_bf16_f32 v88, v128, v129
    v_cvt_pk_bf16_f32 v89, v130, v131
    v_mfma_f32_16x16x32_bf16 v[140:143], a[172:175], a[168:171], v[140:143]
    v_mul_f32 v148, s68, v148
    v_mul_f32 v149, s68, v149
    v_mfma_f32_16x16x32_bf16 v[160:163], a[176:179], a[168:171], v[160:163]
    v_mul_f32 v150, s68, v150
    v_mul_f32 v151, s68, v151
    v_mfma_f32_16x16x32_bf16 v[164:167], a[108:111], a[80:83], v[164:167]
    v_cvt_pk_bf16_f32 v90, v148, v149
    v_cvt_pk_bf16_f32 v91, v150, v151
    v_mfma_f32_16x16x32_bf16 v[184:187], a[112:115], a[80:83], v[184:187]
    ds_write_b128 v6, v[88:91] offset:1024
    v_mfma_f32_16x16x32_bf16 v[164:167], a[180:183], a[152:155], v[164:167]
    s_add_u32 m0, s61, 65536
    v_mul_f32 v132, s68, v132
    v_mul_f32 v133, s68, v133
    v_mfma_f32_16x16x32_bf16 v[184:187], a[184:187], a[152:155], v[184:187]
    s_mov_b32 s58, 16384
    buffer_load_dwordx4 v3, s[28:31], s58 offen offset:0 nt lds
    v_mul_f32 v134, s68, v134
    v_mfma_f32_16x16x32_bf16 v[168:171], a[108:111], a[84:87], v[168:171]
    v_mul_f32 v135, s68, v135
    v_cvt_pk_bf16_f32 v92, v132, v133
    v_mfma_f32_16x16x32_bf16 v[188:191], a[112:115], a[84:87], v[188:191]
    v_cvt_pk_bf16_f32 v93, v134, v135
    v_mul_f32 v152, s68, v152
    v_mfma_f32_16x16x32_bf16 v[168:171], a[180:183], a[156:159], v[168:171]
    v_mul_f32 v153, s68, v153
    v_mul_f32 v154, s68, v154
    v_mfma_f32_16x16x32_bf16 v[188:191], a[184:187], a[156:159], v[188:191]
    buffer_load_dwordx4 v3, s[28:31], s58 offen offset:1024 nt lds
    v_mul_f32 v155, s68, v155
    v_mfma_f32_16x16x32_bf16 v[172:175], a[108:111], a[88:91], v[172:175]
    v_cvt_pk_bf16_f32 v94, v152, v153
    v_cvt_pk_bf16_f32 v95, v154, v155
    v_mfma_f32_16x16x32_bf16 v[192:195], a[112:115], a[88:91], v[192:195]
    ds_write_b128 v6, v[92:95] offset:2048
    v_mfma_f32_16x16x32_bf16 v[172:175], a[180:183], a[160:163], v[172:175]
    v_mul_f32 v136, s68, v136
    v_mul_f32 v137, s68, v137
    v_mfma_f32_16x16x32_bf16 v[192:195], a[184:187], a[160:163], v[192:195]
    buffer_load_dwordx4 v3, s[28:31], s58 offen offset:2048 nt lds
    v_mul_f32 v138, s68, v138
    v_mfma_f32_16x16x32_bf16 v[176:179], a[108:111], a[92:95], v[176:179]
    v_mul_f32 v139, s68, v139
    v_cvt_pk_bf16_f32 v96, v136, v137
    v_mfma_f32_16x16x32_bf16 v[196:199], a[112:115], a[92:95], v[196:199]
    v_cvt_pk_bf16_f32 v97, v138, v139
    v_mul_f32 v156, s68, v156
    v_mfma_f32_16x16x32_bf16 v[176:179], a[180:183], a[164:167], v[176:179]
    v_mul_f32 v157, s68, v157
    v_mul_f32 v158, s68, v158
    v_mfma_f32_16x16x32_bf16 v[196:199], a[184:187], a[164:167], v[196:199]
    buffer_load_dwordx4 v3, s[28:31], s58 offen offset:3072 nt lds
    v_mul_f32 v159, s68, v159
    v_mfma_f32_16x16x32_bf16 v[180:183], a[108:111], a[96:99], v[180:183]
    v_cvt_pk_bf16_f32 v98, v156, v157
    v_cvt_pk_bf16_f32 v99, v158, v159
    v_mfma_f32_16x16x32_bf16 v[200:203], a[112:115], a[96:99], v[200:203]
    ds_write_b128 v6, v[96:99] offset:3072
    v_mfma_f32_16x16x32_bf16 v[180:183], a[180:183], a[168:171], v[180:183]
    v_mfma_f32_16x16x32_bf16 v[200:203], a[184:187], a[168:171], v[200:203]
    v_pk_mul_f32 v[140:141], v[140:141], s[68:69]
    v_pk_mul_f32 v[142:143], v[142:143], s[68:69]
    v_cvt_pk_bf16_f32 v100, v140, v141
    v_cvt_pk_bf16_f32 v101, v142, v143
    v_pk_mul_f32 v[160:161], v[160:161], s[68:69]
    v_pk_mul_f32 v[162:163], v[162:163], s[68:69]
    v_cvt_pk_bf16_f32 v102, v160, v161
    v_cvt_pk_bf16_f32 v103, v162, v163
    ds_write_b128 v6, v[100:103] offset:4096
    v_pk_mul_f32 v[164:165], v[164:165], s[68:69]
    v_pk_mul_f32 v[166:167], v[166:167], s[68:69]
    v_cvt_pk_bf16_f32 v104, v164, v165
    v_cvt_pk_bf16_f32 v105, v166, v167
    v_pk_mul_f32 v[184:185], v[184:185], s[68:69]
    v_pk_mul_f32 v[186:187], v[186:187], s[68:69]
    v_cvt_pk_bf16_f32 v106, v184, v185
    v_cvt_pk_bf16_f32 v107, v186, v187
    ds_write_b128 v6, v[104:107] offset:5120
    v_pk_mul_f32 v[168:169], v[168:169], s[68:69]
    v_pk_mul_f32 v[170:171], v[170:171], s[68:69]
    v_cvt_pk_bf16_f32 v108, v168, v169
    v_cvt_pk_bf16_f32 v109, v170, v171
    v_pk_mul_f32 v[188:189], v[188:189], s[68:69]
    v_pk_mul_f32 v[190:191], v[190:191], s[68:69]
    v_cvt_pk_bf16_f32 v110, v188, v189
    v_cvt_pk_bf16_f32 v111, v190, v191
    ds_write_b128 v6, v[108:111] offset:6144
    v_pk_mul_f32 v[172:173], v[172:173], s[68:69]
    v_pk_mul_f32 v[174:175], v[174:175], s[68:69]
    v_cvt_pk_bf16_f32 v112, v172, v173
    v_cvt_pk_bf16_f32 v113, v174, v175
    v_pk_mul_f32 v[192:193], v[192:193], s[68:69]
    v_pk_mul_f32 v[194:195], v[194:195], s[68:69]
    v_cvt_pk_bf16_f32 v114, v192, v193
    v_cvt_pk_bf16_f32 v115, v194, v195
    ds_write_b128 v6, v[112:115] offset:7168
    v_pk_mul_f32 v[176:177], v[176:177], s[68:69]
    v_pk_mul_f32 v[178:179], v[178:179], s[68:69]
    v_cvt_pk_bf16_f32 v116, v176, v177
    v_cvt_pk_bf16_f32 v117, v178, v179
    v_pk_mul_f32 v[196:197], v[196:197], s[68:69]
    v_pk_mul_f32 v[198:199], v[198:199], s[68:69]
    v_cvt_pk_bf16_f32 v118, v196, v197
    v_cvt_pk_bf16_f32 v119, v198, v199
    ds_write_b128 v6, v[116:119] offset:8192
    v_pk_mul_f32 v[180:181], v[180:181], s[68:69]
    v_pk_mul_f32 v[182:183], v[182:183], s[68:69]
    v_cvt_pk_bf16_f32 v120, v180, v181
    v_cvt_pk_bf16_f32 v121, v182, v183
    v_pk_mul_f32 v[200:201], v[200:201], s[68:69]
    v_pk_mul_f32 v[202:203], v[202:203], s[68:69]
    v_cvt_pk_bf16_f32 v122, v200, v201
    v_cvt_pk_bf16_f32 v123, v202, v203
    ds_write_b128 v6, v[120:123] offset:9216
    s_lshl_b32 s58, s55, 11
    v_subrev_u32 v244, s58, v7
    v_subrev_u32 v245, s58, v8
    v_subrev_u32 v246, s58, v9
    v_subrev_u32 v247, s58, v10
    s_waitcnt lgkmcnt(0)
    s_barrier
    ds_read_b128 a[240:243], v244 offset:0
    ds_read_b128 a[244:247], v245 offset:0
    ds_read_b128 a[248:251], v246 offset:0
    ds_read_b128 a[252:255], v247 offset:0
    ds_read_b128 a[40:43], v5 offset:0
    ds_read_b128 a[44:47], v5 offset:1024
    ds_read_b128 a[48:51], v5 offset:2048
    ds_read_b128 a[52:55], v5 offset:3072
    s_waitcnt lgkmcnt(4)
    v_mfma_f32_16x16x32_bf16 v[44:47], a[240:243], v[84:87], 0
    ds_read_b128 a[56:59], v5 offset:4096
    v_mfma_f32_16x16x32_bf16 v[48:51], a[240:243], v[88:91], 0
    ds_read_b128 a[60:63], v5 offset:5120
    v_mfma_f32_16x16x32_bf16 v[52:55], a[240:243], v[92:95], 0
    s_add_u32 m0, s61, 81920
    ds_read_b128 a[64:67], v5 offset:6144
    v_mfma_f32_16x16x32_bf16 v[56:59], a[240:243], v[96:99], 0
    s_mov_b32 s58, 32768
    ds_read_b128 a[68:71], v5 offset:7168
    buffer_load_dwordx4 v3, s[28:31], s58 offen offset:0 nt lds
    v_mfma_f32_16x16x32_bf16 v[60:63], a[240:243], v[100:103], 0
    ds_read_b128 a[72:75], v5 offset:8192
    v_mfma_f32_16x16x32_bf16 v[44:47], a[244:247], v[104:107], v[44:47]
    ds_read_b128 a[76:79], v5 offset:9216
    v_mfma_f32_16x16x32_bf16 v[48:51], a[244:247], v[108:111], v[48:51]
    v_mfma_f32_16x16x32_bf16 v[52:55], a[244:247], v[112:115], v[52:55]
    buffer_load_dwordx4 v3, s[28:31], s58 offen offset:1024 nt lds
    v_mfma_f32_16x16x32_bf16 v[56:59], a[244:247], v[116:119], v[56:59]
    v_mfma_f32_16x16x32_bf16 v[60:63], a[244:247], v[120:123], v[60:63]
    s_waitcnt lgkmcnt(0)
    v_mfma_f32_16x16x32_bf16 v[64:67], a[248:251], a[40:43], 0
    ds_read_b128 a[208:211], v7 offset:0
    v_mfma_f32_16x16x32_bf16 v[68:71], a[248:251], a[44:47], 0
    ds_read_b128 a[212:215], v8 offset:0
    buffer_load_dwordx4 v3, s[28:31], s58 offen offset:2048 nt lds
    v_mfma_f32_16x16x32_bf16 v[72:75], a[248:251], a[48:51], 0
    ds_read_b128 a[216:219], v9 offset:0
    v_mfma_f32_16x16x32_bf16 v[76:79], a[248:251], a[52:55], 0
    ds_read_b128 a[220:223], v10 offset:0
    v_mfma_f32_16x16x32_bf16 v[80:83], a[248:251], a[56:59], 0
    ds_read_b128 a[224:227], v7 offset:1024
    v_mfma_f32_16x16x32_bf16 v[64:67], a[252:255], a[60:63], v[64:67]
    ds_read_b128 a[228:231], v8 offset:1024
    buffer_load_dwordx4 v3, s[28:31], s58 offen offset:3072 nt lds
    v_mfma_f32_16x16x32_bf16 v[68:71], a[252:255], a[64:67], v[68:71]
    ds_read_b128 a[232:235], v9 offset:1024
    v_mfma_f32_16x16x32_bf16 v[72:75], a[252:255], a[68:71], v[72:75]
    ds_read_b128 a[236:239], v10 offset:1024
    v_mfma_f32_16x16x32_bf16 v[76:79], a[252:255], a[72:75], v[76:79]
    v_mfma_f32_16x16x32_bf16 v[80:83], a[252:255], a[76:79], v[80:83]
    v_pk_add_f32 v[44:45], v[44:45], v[64:65]
    v_pk_add_f32 v[46:47], v[46:47], v[66:67]
    s_nop 0
    v_pk_add_f32 v[48:49], v[48:49], v[68:69]
    v_pk_add_f32 v[50:51], v[50:51], v[70:71]
    v_pk_add_f32 v[52:53], v[52:53], v[72:73]
    v_pk_add_f32 v[54:55], v[54:55], v[74:75]
    v_pk_add_f32 v[56:57], v[56:57], v[76:77]
    v_pk_add_f32 v[58:59], v[58:59], v[78:79]
    v_pk_add_f32 v[60:61], v[60:61], v[80:81]
    v_pk_add_f32 v[62:63], v[62:63], v[82:83]
    v_max3_f32 v244, v44, v45, v46
    v_max3_f32 v245, v48, v49, v50
    v_max3_f32 v246, v52, v53, v54
    v_max3_f32 v247, v56, v57, v58
    v_max3_f32 v248, v60, v61, v62
    v_max_f32 v244, v244, v47
    v_max_f32 v245, v245, v51
    v_max_f32 v246, v246, v55
    v_max_f32 v247, v247, v59
    v_max_f32 v248, v248, v63
    v_mov_b32 v249, v244
    v_mov_b32 v250, v245
    v_mov_b32 v251, v246
    v_mov_b32 v252, v247
    v_mov_b32 v253, v248
    v_permlane16_swap_b32 v244, v249
    v_permlane16_swap_b32 v245, v250
    v_permlane16_swap_b32 v246, v251
    v_permlane16_swap_b32 v247, v252
    v_permlane16_swap_b32 v248, v253
    v_max_f32 v244, v244, v249
    v_max_f32 v245, v245, v250
    v_max_f32 v246, v246, v251
    v_max_f32 v247, v247, v252
    v_max_f32 v248, v248, v253
    v_mov_b32 v249, v244
    v_mov_b32 v250, v245
    v_mov_b32 v251, v246
    v_mov_b32 v252, v247
    v_mov_b32 v253, v248
    v_permlane32_swap_b32 v244, v249
    v_permlane32_swap_b32 v245, v250
    v_permlane32_swap_b32 v246, v251
    v_permlane32_swap_b32 v247, v252
    v_permlane32_swap_b32 v248, v253
    v_max_f32 v244, v244, v249
    v_max_f32 v245, v245, v250
    v_max_f32 v246, v246, v251
    v_max_f32 v247, v247, v252
    v_max_f32 v248, v248, v253
    v_sub_f32 v204, 0, v244
    v_sub_f32 v205, 0, v244
    v_sub_f32 v206, 0, v244
    v_sub_f32 v207, 0, v244
    v_sub_f32 v208, 0, v245
    v_sub_f32 v209, 0, v245
    v_sub_f32 v210, 0, v245
    v_sub_f32 v211, 0, v245
    v_sub_f32 v212, 0, v246
    v_sub_f32 v213, 0, v246
    v_sub_f32 v214, 0, v246
    v_sub_f32 v215, 0, v246
    v_sub_f32 v216, 0, v247
    v_sub_f32 v217, 0, v247
    v_sub_f32 v218, 0, v247
    v_sub_f32 v219, 0, v247
    v_sub_f32 v220, 0, v248
    v_sub_f32 v221, 0, v248
    v_sub_f32 v222, 0, v248
    v_sub_f32 v223, 0, v248
    s_waitcnt vmcnt(12)
    v_readfirstlane_b32 s4, v22
    v_readfirstlane_b32 s5, v23
    s_and_b32 s58, s4, 1
    s_lshr_b32 s59, s5, 31
    s_and_b32 s58, s58, s59
    s_cbranch_scc0 L_nonce_slow
L_nonce_ok:
L_attn:
    s_waitcnt lgkmcnt(0)
    s_barrier
    v_mfma_f32_16x16x32_bf16 v[24:27], a[208:211], v[84:87], v[204:207]
    v_mfma_f32_16x16x32_bf16 v[24:27], a[212:215], v[104:107], v[24:27]
    v_mfma_f32_16x16x32_bf16 v[24:27], a[216:219], a[40:43], v[24:27]
    s_add_u32 m0, s61, 0
    v_mfma_f32_16x16x32_bf16 v[24:27], a[220:223], a[60:63], v[24:27]
    s_mov_b32 s58, 49152
    buffer_load_dwordx4 v2, s[24:27], s58 offen offset:0 nt lds
    v_mfma_f32_16x16x32_bf16 v[64:67], a[224:227], v[84:87], v[204:207]
    v_mfma_f32_16x16x32_bf16 v[64:67], a[228:231], v[104:107], v[64:67]
    v_mfma_f32_16x16x32_bf16 v[64:67], a[232:235], a[40:43], v[64:67]
    v_mfma_f32_16x16x32_bf16 v[64:67], a[236:239], a[60:63], v[64:67]
    buffer_load_dwordx4 v2, s[24:27], s58 offen offset:1024 nt lds
    v_mfma_f32_16x16x32_bf16 v[28:31], a[208:211], v[88:91], v[208:211]
    v_exp_f32 v24, v24
    v_mfma_f32_16x16x32_bf16 v[28:31], a[212:215], v[108:111], v[28:31]
    v_exp_f32 v25, v25
    v_mfma_f32_16x16x32_bf16 v[28:31], a[216:219], a[44:47], v[28:31]
    v_exp_f32 v26, v26
    v_mfma_f32_16x16x32_bf16 v[28:31], a[220:223], a[64:67], v[28:31]
    v_exp_f32 v27, v27
    v_mfma_f32_16x16x32_bf16 v[68:71], a[224:227], v[88:91], v[208:211]
    v_cvt_pk_bf16_f32 v24, v24, v25
    v_cvt_pk_bf16_f32 v25, v26, v27
    v_mfma_f32_16x16x32_bf16 v[68:71], a[228:231], v[108:111], v[68:71]
    v_exp_f32 v64, v64
    v_mfma_f32_16x16x32_bf16 v[68:71], a[232:235], a[44:47], v[68:71]
    v_exp_f32 v65, v65
    v_mfma_f32_16x16x32_bf16 v[68:71], a[236:239], a[64:67], v[68:71]
    v_exp_f32 v66, v66
    v_mfma_f32_16x16x32_bf16 v[32:35], a[208:211], v[92:95], v[212:215]
    v_exp_f32 v67, v67
    v_mfma_f32_16x16x32_bf16 v[32:35], a[212:215], v[112:115], v[32:35]
    v_cvt_pk_bf16_f32 v26, v64, v65
    v_cvt_pk_bf16_f32 v27, v66, v67
    v_mfma_f32_16x16x32_bf16 v[32:35], a[216:219], a[48:51], v[32:35]
    ds_write_b128 v5, v[24:27] offset:0
    v_mfma_f32_16x16x32_bf16 v[32:35], a[220:223], a[68:71], v[32:35]
    v_exp_f32 v28, v28
    v_mfma_f32_16x16x32_bf16 v[72:75], a[224:227], v[92:95], v[212:215]
    buffer_load_dwordx4 v2, s[24:27], s58 offen offset:2048 nt lds
    v_exp_f32 v29, v29
    v_mfma_f32_16x16x32_bf16 v[72:75], a[228:231], v[112:115], v[72:75]
    v_exp_f32 v30, v30
    v_mfma_f32_16x16x32_bf16 v[72:75], a[232:235], a[48:51], v[72:75]
    v_exp_f32 v31, v31
    v_mfma_f32_16x16x32_bf16 v[72:75], a[236:239], a[68:71], v[72:75]
    v_cvt_pk_bf16_f32 v28, v28, v29
    v_cvt_pk_bf16_f32 v29, v30, v31
    v_mfma_f32_16x16x32_bf16 v[36:39], a[208:211], v[96:99], v[216:219]
    v_exp_f32 v68, v68
    v_mfma_f32_16x16x32_bf16 v[36:39], a[212:215], v[116:119], v[36:39]
    v_exp_f32 v69, v69
    v_mfma_f32_16x16x32_bf16 v[36:39], a[216:219], a[52:55], v[36:39]
    v_exp_f32 v70, v70
    v_mfma_f32_16x16x32_bf16 v[36:39], a[220:223], a[72:75], v[36:39]
    v_exp_f32 v71, v71
    v_mfma_f32_16x16x32_bf16 v[76:79], a[224:227], v[96:99], v[216:219]
    v_cvt_pk_bf16_f32 v30, v68, v69
    v_cvt_pk_bf16_f32 v31, v70, v71
    v_mfma_f32_16x16x32_bf16 v[76:79], a[228:231], v[116:119], v[76:79]
    ds_write_b128 v5, v[28:31] offset:1024
    v_mfma_f32_16x16x32_bf16 v[76:79], a[232:235], a[52:55], v[76:79]
    v_exp_f32 v32, v32
    v_mfma_f32_16x16x32_bf16 v[76:79], a[236:239], a[72:75], v[76:79]
    buffer_load_dwordx4 v2, s[24:27], s58 offen offset:3072 nt lds
    v_exp_f32 v33, v33
    v_mfma_f32_16x16x32_bf16 v[40:43], a[208:211], v[100:103], v[220:223]
    v_exp_f32 v34, v34
    v_mfma_f32_16x16x32_bf16 v[40:43], a[212:215], v[120:123], v[40:43]
    v_exp_f32 v35, v35
    v_mfma_f32_16x16x32_bf16 v[40:43], a[216:219], a[56:59], v[40:43]
    v_cvt_pk_bf16_f32 v32, v32, v33
    v_cvt_pk_bf16_f32 v33, v34, v35
    v_mfma_f32_16x16x32_bf16 v[40:43], a[220:223], a[76:79], v[40:43]
    v_exp_f32 v72, v72
    v_mfma_f32_16x16x32_bf16 v[80:83], a[224:227], v[100:103], v[220:223]
    v_exp_f32 v73, v73
    v_mfma_f32_16x16x32_bf16 v[80:83], a[228:231], v[120:123], v[80:83]
    v_exp_f32 v74, v74
    v_mfma_f32_16x16x32_bf16 v[80:83], a[232:235], a[56:59], v[80:83]
    v_exp_f32 v75, v75
    v_mfma_f32_16x16x32_bf16 v[80:83], a[236:239], a[76:79], v[80:83]
    v_cvt_pk_bf16_f32 v34, v72, v73
    v_cvt_pk_bf16_f32 v35, v74, v75
    ds_write_b128 v5, v[32:35] offset:2048
    ds_read_b128 a[208:211], v7 offset:16384
    ds_read_b128 a[212:215], v8 offset:16384
    ds_read_b128 a[216:219], v9 offset:16384
    ds_read_b128 a[220:223], v10 offset:16384
    ds_read_b128 a[224:227], v7 offset:17408
    ds_read_b128 a[228:231], v8 offset:17408
    ds_read_b128 a[232:235], v9 offset:17408
    ds_read_b128 a[236:239], v10 offset:17408
    s_add_u32 m0, s61, 98304
    s_mov_b32 s58, 49152
    buffer_load_dwordx4 v3, s[28:31], s58 offen offset:0 nt lds
    v_exp_f32 v36, v36
    v_exp_f32 v37, v37
    v_exp_f32 v38, v38
    v_exp_f32 v39, v39
    v_cvt_pk_bf16_f32 v36, v36, v37
    buffer_load_dwordx4 v3, s[28:31], s58 offen offset:1024 nt lds
    v_cvt_pk_bf16_f32 v37, v38, v39
    v_exp_f32 v76, v76
    v_exp_f32 v77, v77
    v_exp_f32 v78, v78
    v_exp_f32 v79, v79
    buffer_load_dwordx4 v3, s[28:31], s58 offen offset:2048 nt lds
    v_cvt_pk_bf16_f32 v38, v76, v77
    v_cvt_pk_bf16_f32 v39, v78, v79
    ds_write_b128 v5, v[36:39] offset:3072
    v_exp_f32 v40, v40
    v_exp_f32 v41, v41
    v_exp_f32 v42, v42
    buffer_load_dwordx4 v3, s[28:31], s58 offen offset:3072 nt lds
    v_exp_f32 v43, v43
    v_cvt_pk_bf16_f32 v40, v40, v41
    v_cvt_pk_bf16_f32 v41, v42, v43
    s_waitcnt lgkmcnt(1)
    v_mfma_f32_16x16x32_bf16 v[44:47], a[208:211], v[84:87], v[204:207]
    v_exp_f32 v80, v80
    v_mfma_f32_16x16x32_bf16 v[44:47], a[212:215], v[104:107], v[44:47]
    v_exp_f32 v81, v81
    v_mfma_f32_16x16x32_bf16 v[44:47], a[216:219], a[40:43], v[44:47]
    v_exp_f32 v82, v82
    v_mfma_f32_16x16x32_bf16 v[44:47], a[220:223], a[60:63], v[44:47]
    v_exp_f32 v83, v83
    v_mfma_f32_16x16x32_bf16 v[64:67], a[224:227], v[84:87], v[204:207]
    v_cvt_pk_bf16_f32 v42, v80, v81
    v_mfma_f32_16x16x32_bf16 v[64:67], a[228:231], v[104:107], v[64:67]
    v_cvt_pk_bf16_f32 v43, v82, v83
    v_mfma_f32_16x16x32_bf16 v[64:67], a[232:235], a[40:43], v[64:67]
    ds_write_b128 v5, v[40:43] offset:4096
    v_mfma_f32_16x16x32_bf16 v[64:67], a[236:239], a[60:63], v[64:67]
    v_mfma_f32_16x16x32_bf16 v[48:51], a[208:211], v[88:91], v[208:211]
    v_exp_f32 v44, v44
    v_mfma_f32_16x16x32_bf16 v[48:51], a[212:215], v[108:111], v[48:51]
    v_exp_f32 v45, v45
    v_mfma_f32_16x16x32_bf16 v[48:51], a[216:219], a[44:47], v[48:51]
    v_exp_f32 v46, v46
    v_mfma_f32_16x16x32_bf16 v[48:51], a[220:223], a[64:67], v[48:51]
    v_exp_f32 v47, v47
    v_mfma_f32_16x16x32_bf16 v[68:71], a[224:227], v[88:91], v[208:211]
    v_exp_f32 v64, v64
    v_mfma_f32_16x16x32_bf16 v[68:71], a[228:231], v[108:111], v[68:71]
    v_cvt_pk_bf16_f32 v44, v44, v45
    v_exp_f32 v65, v65
    v_mfma_f32_16x16x32_bf16 v[68:71], a[232:235], a[44:47], v[68:71]
    v_cvt_pk_bf16_f32 v45, v46, v47
    v_exp_f32 v66, v66
    v_mfma_f32_16x16x32_bf16 v[68:71], a[236:239], a[64:67], v[68:71]
    s_waitcnt vmcnt(16) lgkmcnt(0)
    s_barrier
    v_exp_f32 v48, v48
    v_mfma_f32_16x16x32_bf16 v[52:55], a[208:211], v[92:95], v[212:215]
    s_add_u32 m0, s61, 16384
    v_exp_f32 v49, v49
    v_mfma_f32_16x16x32_bf16 v[52:55], a[212:215], v[112:115], v[52:55]
    s_mov_b32 s58, 65536
    buffer_load_dwordx4 v2, s[24:27], s58 offen offset:0 nt lds
    v_mfma_f32_16x16x32_bf16 v[52:55], a[216:219], a[48:51], v[52:55]
    v_exp_f32 v67, v67
    v_mfma_f32_16x16x32_bf16 v[52:55], a[220:223], a[68:71], v[52:55]
    v_cvt_pk_bf16_f32 v46, v64, v65
    v_cvt_pk_bf16_f32 v47, v66, v67
    v_mfma_f32_16x16x32_bf16 v[72:75], a[224:227], v[92:95], v[212:215]
    v_exp_f32 v50, v50
    v_mfma_f32_16x16x32_bf16 v[72:75], a[228:231], v[112:115], v[72:75]
    ds_write_b128 v5, v[44:47] offset:5120
    v_mfma_f32_16x16x32_bf16 v[72:75], a[232:235], a[48:51], v[72:75]
    v_exp_f32 v51, v51
    v_mfma_f32_16x16x32_bf16 v[72:75], a[236:239], a[68:71], v[72:75]
    v_exp_f32 v68, v68
    v_mfma_f32_16x16x32_bf16 v[56:59], a[208:211], v[96:99], v[216:219]
    v_exp_f32 v69, v69
    v_mfma_f32_16x16x32_bf16 v[56:59], a[212:215], v[116:119], v[56:59]
    v_exp_f32 v70, v70
    v_mfma_f32_16x16x32_bf16 v[56:59], a[216:219], a[52:55], v[56:59]
    buffer_load_dwordx4 v2, s[24:27], s58 offen offset:1024 nt lds
    v_mfma_f32_16x16x32_bf16 v[56:59], a[220:223], a[72:75], v[56:59]
    ds_read_b64_tr_b16 a[240:241], v11 offset:0
    v_cvt_pk_bf16_f32 v48, v48, v49
    v_mfma_f32_16x16x32_bf16 v[76:79], a[224:227], v[96:99], v[216:219]
    ds_read_b64_tr_b16 a[242:243], v11 offset:1024
    v_cvt_pk_bf16_f32 v49, v50, v51
    v_mfma_f32_16x16x32_bf16 v[76:79], a[228:231], v[116:119], v[76:79]
    v_exp_f32 v71, v71
    v_mfma_f32_16x16x32_bf16 v[76:79], a[232:235], a[52:55], v[76:79]
    ds_read_b64_tr_b16 a[244:245], v12 offset:0
    v_cvt_pk_bf16_f32 v50, v68, v69
    v_mfma_f32_16x16x32_bf16 v[76:79], a[236:239], a[72:75], v[76:79]
    ds_read_b64_tr_b16 a[246:247], v12 offset:1024
    v_cvt_pk_bf16_f32 v51, v70, v71
    v_mfma_f32_16x16x32_bf16 v[60:63], a[208:211], v[100:103], v[220:223]
    v_exp_f32 v52, v52
    v_mfma_f32_16x16x32_bf16 v[60:63], a[212:215], v[120:123], v[60:63]
    v_exp_f32 v53, v53
    v_mfma_f32_16x16x32_bf16 v[60:63], a[216:219], a[56:59], v[60:63]
    buffer_load_dwordx4 v2, s[24:27], s58 offen offset:2048 nt lds
    v_mfma_f32_16x16x32_bf16 v[60:63], a[220:223], a[76:79], v[60:63]
    ds_read_b64_tr_b16 a[248:249], v13 offset:0
    ds_read_b64_tr_b16 a[250:251], v13 offset:1024
    v_mfma_f32_16x16x32_bf16 v[80:83], a[224:227], v[100:103], v[220:223]
    ds_read_b64_tr_b16 a[252:253], v14 offset:0
    ds_read_b64_tr_b16 a[254:255], v14 offset:1024
    v_mfma_f32_16x16x32_bf16 v[80:83], a[228:231], v[120:123], v[80:83]
    v_exp_f32 v54, v54
    v_mfma_f32_16x16x32_bf16 v[80:83], a[232:235], a[56:59], v[80:83]
    ds_write_b128 v5, v[48:51] offset:6144
    v_mfma_f32_16x16x32_bf16 v[80:83], a[236:239], a[76:79], v[80:83]
    v_exp_f32 v55, v55
    v_mfma_f32_16x16x32_bf16 v[224:227], a[36:39], v[24:27], 0
    v_exp_f32 v72, v72
    v_mfma_f32_16x16x32_bf16 v[228:231], a[36:39], v[28:31], 0
    v_exp_f32 v73, v73
    v_mfma_f32_16x16x32_bf16 v[232:235], a[36:39], v[32:35], 0
    v_exp_f32 v74, v74
    v_mfma_f32_16x16x32_bf16 v[236:239], a[36:39], v[36:39], 0
    buffer_load_dwordx4 v2, s[24:27], s58 offen offset:3072 nt lds
    v_mfma_f32_16x16x32_bf16 v[240:243], a[36:39], v[40:43], 0
    s_waitcnt lgkmcnt(7)
    ds_read_b128 a[0:3], v6 offset:0
    v_cvt_pk_bf16_f32 v52, v52, v53
    v_mfma_f32_16x16x32_bf16 v[124:127], a[240:243], v[24:27], 0
    ds_read_b128 a[4:7], v6 offset:1024
    v_cvt_pk_bf16_f32 v53, v54, v55
    v_mfma_f32_16x16x32_bf16 v[128:131], a[240:243], v[28:31], 0
    v_exp_f32 v75, v75
    v_mfma_f32_16x16x32_bf16 v[132:135], a[240:243], v[32:35], 0
    ds_read_b128 a[8:11], v6 offset:2048
    v_cvt_pk_bf16_f32 v54, v72, v73
    v_mfma_f32_16x16x32_bf16 v[136:139], a[240:243], v[36:39], 0
    ds_read_b128 a[12:15], v6 offset:3072
    v_cvt_pk_bf16_f32 v55, v74, v75
    v_mfma_f32_16x16x32_bf16 v[140:143], a[240:243], v[40:43], 0
    s_waitcnt lgkmcnt(9)
    v_exp_f32 v56, v56
    v_mfma_f32_16x16x32_bf16 v[144:147], a[244:247], v[24:27], 0
    v_exp_f32 v57, v57
    v_mfma_f32_16x16x32_bf16 v[148:151], a[244:247], v[28:31], 0
    ds_read_b128 a[16:19], v6 offset:4096
    ds_read_b64_tr_b16 a[20:21], v15 offset:0
    v_mfma_f32_16x16x32_bf16 v[152:155], a[244:247], v[32:35], 0
    ds_read_b64_tr_b16 a[22:23], v15 offset:1024
    ds_read_b64_tr_b16 a[24:25], v16 offset:0
    v_mfma_f32_16x16x32_bf16 v[156:159], a[244:247], v[36:39], 0
    ds_read_b64_tr_b16 a[26:27], v16 offset:1024
    ds_read_b128 a[208:211], v7 offset:32768
    v_mfma_f32_16x16x32_bf16 v[160:163], a[244:247], v[40:43], 0
    s_waitcnt lgkmcnt(11)
    v_exp_f32 v58, v58
    v_mfma_f32_16x16x32_bf16 v[164:167], a[248:251], v[24:27], 0
    ds_write_b128 v5, v[52:55] offset:7168
    v_mfma_f32_16x16x32_bf16 v[168:171], a[248:251], v[28:31], 0
    v_exp_f32 v59, v59
    v_mfma_f32_16x16x32_bf16 v[172:175], a[248:251], v[32:35], 0
    v_exp_f32 v76, v76
    v_mfma_f32_16x16x32_bf16 v[176:179], a[248:251], v[36:39], 0
    v_exp_f32 v77, v77
    v_mfma_f32_16x16x32_bf16 v[180:183], a[248:251], v[40:43], 0
    v_exp_f32 v78, v78
    v_mfma_f32_16x16x32_bf16 v[184:187], a[252:255], v[24:27], 0
    ds_read_b128 a[212:215], v8 offset:32768
    ds_read_b128 a[216:219], v9 offset:32768
    v_mfma_f32_16x16x32_bf16 v[188:191], a[252:255], v[28:31], 0
    ds_read_b128 a[220:223], v10 offset:32768
    v_cvt_pk_bf16_f32 v56, v56, v57
    v_mfma_f32_16x16x32_bf16 v[192:195], a[252:255], v[32:35], 0
    ds_read_b128 a[224:227], v7 offset:33792
    v_cvt_pk_bf16_f32 v57, v58, v59
    v_mfma_f32_16x16x32_bf16 v[196:199], a[252:255], v[36:39], 0
    v_exp_f32 v79, v79
    v_mfma_f32_16x16x32_bf16 v[200:203], a[252:255], v[40:43], 0
    s_waitcnt lgkmcnt(6)
    ds_read_b128 a[228:231], v8 offset:33792
    v_cvt_pk_bf16_f32 v58, v76, v77
    v_mfma_f32_16x16x32_bf16 v[124:127], a[20:23], a[0:3], v[124:127]
    ds_read_b128 a[232:235], v9 offset:33792
    v_cvt_pk_bf16_f32 v59, v78, v79
    v_mfma_f32_16x16x32_bf16 v[128:131], a[20:23], a[4:7], v[128:131]
    v_exp_f32 v60, v60
    v_mfma_f32_16x16x32_bf16 v[132:135], a[20:23], a[8:11], v[132:135]
    v_exp_f32 v61, v61
    v_mfma_f32_16x16x32_bf16 v[136:139], a[20:23], a[12:15], v[136:139]
    ds_read_b128 a[236:239], v10 offset:33792
    ds_read_b64_tr_b16 a[28:29], v17 offset:0
    v_mfma_f32_16x16x32_bf16 v[140:143], a[20:23], a[16:19], v[140:143]
    ds_read_b64_tr_b16 a[30:31], v17 offset:1024
    ds_read_b64_tr_b16 a[32:33], v18 offset:0
    v_mfma_f32_16x16x32_bf16 v[144:147], a[24:27], a[0:3], v[144:147]
    ds_read_b64_tr_b16 a[34:35], v18 offset:1024
    v_mfma_f32_16x16x32_bf16 v[148:151], a[24:27], a[4:7], v[148:151]
    v_exp_f32 v62, v62
    v_mfma_f32_16x16x32_bf16 v[152:155], a[24:27], a[8:11], v[152:155]
    ds_write_b128 v5, v[56:59] offset:8192
    v_mfma_f32_16x16x32_bf16 v[156:159], a[24:27], a[12:15], v[156:159]
    v_exp_f32 v63, v63
    v_mfma_f32_16x16x32_bf16 v[160:163], a[24:27], a[16:19], v[160:163]
    s_waitcnt lgkmcnt(9)
    v_exp_f32 v80, v80
    v_mfma_f32_16x16x32_bf16 v[24:27], a[208:211], v[84:87], v[204:207]
    v_exp_f32 v81, v81
    v_mfma_f32_16x16x32_bf16 v[24:27], a[212:215], v[104:107], v[24:27]
    v_exp_f32 v82, v82
    v_mfma_f32_16x16x32_bf16 v[24:27], a[216:219], a[40:43], v[24:27]
    v_subrev_u32 v246, 49152, v19
    v_subrev_u32 v247, 49152, v20
    v_mfma_f32_16x16x32_bf16 v[24:27], a[220:223], a[60:63], v[24:27]
    s_waitcnt lgkmcnt(5)
    v_cvt_pk_bf16_f32 v60, v60, v61
    v_lshlrev_b32 v0, 3, v1
    v_mfma_f32_16x16x32_bf16 v[64:67], a[224:227], v[84:87], v[204:207]
    v_cvt_pk_bf16_f32 v61, v62, v63
    v_xor_b32 v0, s2, v0
    v_mfma_f32_16x16x32_bf16 v[64:67], a[228:231], v[104:107], v[64:67]
    v_exp_f32 v83, v83
    v_mfma_f32_16x16x32_bf16 v[64:67], a[232:235], a[40:43], v[64:67]
    v_cvt_pk_bf16_f32 v62, v80, v81
    v_lshlrev_b32 v0, 9, v0
    v_mfma_f32_16x16x32_bf16 v[64:67], a[236:239], a[60:63], v[64:67]
    v_cvt_pk_bf16_f32 v63, v82, v83
    v_lshl_add_u32 v0, v1, 5, v0
    v_mfma_f32_16x16x32_bf16 v[28:31], a[208:211], v[88:91], v[208:211]
    s_lshl_b32 s35, s3, 6
    v_exp_f32 v24, v24
    v_mfma_f32_16x16x32_bf16 v[28:31], a[212:215], v[108:111], v[28:31]
    s_add_u32 s35, s35, -1
    v_exp_f32 v25, v25
    v_mfma_f32_16x16x32_bf16 v[28:31], a[216:219], a[44:47], v[28:31]
    v_add_u32 v244, s35, v1
    v_min_u32 v244, 3, v244
    v_mfma_f32_16x16x32_bf16 v[28:31], a[220:223], a[64:67], v[28:31]
    v_add_u32 v244, 1, v244
    v_and_b32 v244, 4, v244
    v_mfma_f32_16x16x32_bf16 v[68:71], a[224:227], v[88:91], v[208:211]
    v_lshl_add_u32 v0, v244, 28, v0
    v_mfma_f32_16x16x32_bf16 v[68:71], a[228:231], v[108:111], v[68:71]
    s_xor_b32 s35, s3, 1
    v_exp_f32 v26, v26
    v_mfma_f32_16x16x32_bf16 v[68:71], a[232:235], a[44:47], v[68:71]
    s_min_u32 s35, s35, 1
    ds_write_b128 v5, v[60:63] offset:9216
    v_mfma_f32_16x16x32_bf16 v[68:71], a[236:239], a[64:67], v[68:71]
    s_waitcnt lgkmcnt(4)
    s_lshl_b32 s35, s35, 30
    v_exp_f32 v27, v27
    v_mfma_f32_16x16x32_bf16 v[164:167], a[28:31], a[0:3], v[164:167]
    v_exp_f32 v64, v64
    v_mfma_f32_16x16x32_bf16 v[168:171], a[28:31], a[4:7], v[168:171]
    v_exp_f32 v65, v65
    v_mfma_f32_16x16x32_bf16 v[172:175], a[28:31], a[8:11], v[172:175]
    v_exp_f32 v66, v66
    v_mfma_f32_16x16x32_bf16 v[176:179], a[28:31], a[12:15], v[176:179]
    v_and_b32 v254, 3, v1
    v_max_u32 v254, 1, v254
    v_mfma_f32_16x16x32_bf16 v[180:183], a[28:31], a[16:19], v[180:183]
    s_waitcnt lgkmcnt(2)
    v_cvt_pk_bf16_f32 v24, v24, v25
    v_lshl_add_u32 v254, v254, 5, s35
    v_mfma_f32_16x16x32_bf16 v[184:187], a[32:35], a[0:3], v[184:187]
    s_mov_b32 s33, 0x1c00000
    v_cvt_pk_bf16_f32 v25, v26, v27
    v_mfma_f32_16x16x32_bf16 v[188:191], a[32:35], a[4:7], v[188:191]
    s_lshl_b32 s34, s2, 9
    v_exp_f32 v67, v67
    v_mfma_f32_16x16x32_bf16 v[192:195], a[32:35], a[8:11], v[192:195]
    s_add_u32 s34, s34, s33
    v_cvt_pk_bf16_f32 v26, v64, v65
    v_mfma_f32_16x16x32_bf16 v[196:199], a[32:35], a[12:15], v[196:199]
    v_cvt_pk_bf16_f32 v27, v66, v67
    v_mfma_f32_16x16x32_bf16 v[200:203], a[32:35], a[16:19], v[200:203]
    s_waitcnt vmcnt(8) lgkmcnt(0)
    s_barrier
    v_exp_f32 v28, v28
    v_mfma_f32_16x16x32_bf16 v[32:35], a[208:211], v[92:95], v[212:215]
    s_add_u32 m0, s61, 32768
    v_exp_f32 v29, v29
    v_mfma_f32_16x16x32_bf16 v[32:35], a[212:215], v[112:115], v[32:35]
    s_mov_b32 s58, 81920
    buffer_load_dwordx4 v2, s[24:27], s58 offen offset:0 nt lds
    v_mfma_f32_16x16x32_bf16 v[32:35], a[216:219], a[48:51], v[32:35]
    ds_read_b64_tr_b16 a[240:241], v11 offset:16384
    ds_read_b64_tr_b16 a[242:243], v11 offset:17408
    v_mfma_f32_16x16x32_bf16 v[32:35], a[220:223], a[68:71], v[32:35]
    ds_read_b64_tr_b16 a[244:245], v12 offset:16384
    ds_read_b64_tr_b16 a[246:247], v12 offset:17408
    v_mfma_f32_16x16x32_bf16 v[72:75], a[224:227], v[92:95], v[212:215]
    v_exp_f32 v30, v30
    v_mfma_f32_16x16x32_bf16 v[72:75], a[228:231], v[112:115], v[72:75]
    ds_write_b128 v5, v[24:27] offset:0
    v_mfma_f32_16x16x32_bf16 v[72:75], a[232:235], a[48:51], v[72:75]
    v_exp_f32 v31, v31
    v_mfma_f32_16x16x32_bf16 v[72:75], a[236:239], a[68:71], v[72:75]
    v_exp_f32 v68, v68
    v_mfma_f32_16x16x32_bf16 v[36:39], a[208:211], v[96:99], v[216:219]
    v_exp_f32 v69, v69
    v_mfma_f32_16x16x32_bf16 v[36:39], a[212:215], v[116:119], v[36:39]
    v_exp_f32 v70, v70
    v_mfma_f32_16x16x32_bf16 v[36:39], a[216:219], a[52:55], v[36:39]
    buffer_load_dwordx4 v2, s[24:27], s58 offen offset:1024 nt lds
    v_mfma_f32_16x16x32_bf16 v[36:39], a[220:223], a[72:75], v[36:39]
    ds_read_b128 a[0:3], v6 offset:5120
    v_cvt_pk_bf16_f32 v28, v28, v29
    v_mfma_f32_16x16x32_bf16 v[76:79], a[224:227], v[96:99], v[216:219]
    ds_read_b128 a[4:7], v6 offset:6144
    v_cvt_pk_bf16_f32 v29, v30, v31
    v_mfma_f32_16x16x32_bf16 v[76:79], a[228:231], v[116:119], v[76:79]
    v_exp_f32 v71, v71
    v_mfma_f32_16x16x32_bf16 v[76:79], a[232:235], a[52:55], v[76:79]
    ds_read_b128 a[8:11], v6 offset:7168
    v_cvt_pk_bf16_f32 v30, v68, v69
    v_mfma_f32_16x16x32_bf16 v[76:79], a[236:239], a[72:75], v[76:79]
    ds_read_b128 a[12:15], v6 offset:8192
    v_cvt_pk_bf16_f32 v31, v70, v71
    v_mfma_f32_16x16x32_bf16 v[40:43], a[208:211], v[100:103], v[220:223]
    v_exp_f32 v32, v32
    v_mfma_f32_16x16x32_bf16 v[40:43], a[212:215], v[120:123], v[40:43]
    v_exp_f32 v33, v33
    v_mfma_f32_16x16x32_bf16 v[40:43], a[216:219], a[56:59], v[40:43]
    buffer_load_dwordx4 v2, s[24:27], s58 offen offset:2048 nt lds
    v_mfma_f32_16x16x32_bf16 v[40:43], a[220:223], a[76:79], v[40:43]
    ds_read_b64_tr_b16 a[248:249], v13 offset:16384
    ds_read_b64_tr_b16 a[250:251], v13 offset:17408
    v_mfma_f32_16x16x32_bf16 v[80:83], a[224:227], v[100:103], v[220:223]
    ds_read_b64_tr_b16 a[252:253], v14 offset:16384
    ds_read_b64_tr_b16 a[254:255], v14 offset:17408
    v_mfma_f32_16x16x32_bf16 v[80:83], a[228:231], v[120:123], v[80:83]
    v_exp_f32 v34, v34
    v_mfma_f32_16x16x32_bf16 v[80:83], a[232:235], a[56:59], v[80:83]
    ds_write_b128 v5, v[28:31] offset:1024
    v_mfma_f32_16x16x32_bf16 v[80:83], a[236:239], a[76:79], v[80:83]
    v_exp_f32 v35, v35
    v_mfma_f32_16x16x32_bf16 v[224:227], a[36:39], v[44:47], v[224:227]
    v_exp_f32 v72, v72
    v_mfma_f32_16x16x32_bf16 v[228:231], a[36:39], v[48:51], v[228:231]
    v_exp_f32 v73, v73
    v_mfma_f32_16x16x32_bf16 v[232:235], a[36:39], v[52:55], v[232:235]
    v_exp_f32 v74, v74
    v_mfma_f32_16x16x32_bf16 v[236:239], a[36:39], v[56:59], v[236:239]
    buffer_load_dwordx4 v2, s[24:27], s58 offen offset:3072 nt lds
    v_mfma_f32_16x16x32_bf16 v[240:243], a[36:39], v[60:63], v[240:243]
    s_waitcnt lgkmcnt(12)
    ds_read_b128 a[16:19], v6 offset:9216
    v_cvt_pk_bf16_f32 v32, v32, v33
    v_mfma_f32_16x16x32_bf16 v[124:127], a[240:243], v[44:47], v[124:127]
    ds_read_b128 a[208:211], v7 offset:0
    v_cvt_pk_bf16_f32 v33, v34, v35
    v_mfma_f32_16x16x32_bf16 v[128:131], a[240:243], v[48:51], v[128:131]
    v_exp_f32 v75, v75
    v_mfma_f32_16x16x32_bf16 v[132:135], a[240:243], v[52:55], v[132:135]
    ds_read_b128 a[212:215], v8 offset:0
    v_cvt_pk_bf16_f32 v34, v72, v73
    v_mfma_f32_16x16x32_bf16 v[136:139], a[240:243], v[56:59], v[136:139]
    ds_read_b128 a[216:219], v9 offset:0
    v_cvt_pk_bf16_f32 v35, v74, v75
    v_mfma_f32_16x16x32_bf16 v[140:143], a[240:243], v[60:63], v[140:143]
    s_waitcnt lgkmcnt(14)
    v_exp_f32 v36, v36
    v_mfma_f32_16x16x32_bf16 v[144:147], a[244:247], v[44:47], v[144:147]
    s_add_u32 m0, s61, 49152
    v_exp_f32 v37, v37
    v_mfma_f32_16x16x32_bf16 v[148:151], a[244:247], v[48:51], v[148:151]
    s_mov_b32 s58, 65536
    buffer_load_dwordx4 v3, s[28:31], s58 offen offset:0 nt lds
    v_mfma_f32_16x16x32_bf16 v[152:155], a[244:247], v[52:55], v[152:155]
    ds_read_b64_tr_b16 a[20:21], v15 offset:16384
    ds_read_b64_tr_b16 a[22:23], v15 offset:17408
    v_mfma_f32_16x16x32_bf16 v[156:159], a[244:247], v[56:59], v[156:159]
    ds_read_b64_tr_b16 a[24:25], v16 offset:16384
    ds_read_b64_tr_b16 a[26:27], v16 offset:17408
    v_mfma_f32_16x16x32_bf16 v[160:163], a[244:247], v[60:63], v[160:163]
    s_waitcnt lgkmcnt(9)
    v_exp_f32 v38, v38
    v_mfma_f32_16x16x32_bf16 v[164:167], a[248:251], v[44:47], v[164:167]
    ds_write_b128 v5, v[32:35] offset:2048
    v_mfma_f32_16x16x32_bf16 v[168:171], a[248:251], v[48:51], v[168:171]
    v_exp_f32 v39, v39
    v_mfma_f32_16x16x32_bf16 v[172:175], a[248:251], v[52:55], v[172:175]
    v_exp_f32 v76, v76
    v_mfma_f32_16x16x32_bf16 v[176:179], a[248:251], v[56:59], v[176:179]
    v_exp_f32 v77, v77
    v_mfma_f32_16x16x32_bf16 v[180:183], a[248:251], v[60:63], v[180:183]
    v_exp_f32 v78, v78
    v_mfma_f32_16x16x32_bf16 v[184:187], a[252:255], v[44:47], v[184:187]
    buffer_load_dwordx4 v3, s[28:31], s58 offen offset:1024 nt lds
    v_mfma_f32_16x16x32_bf16 v[188:191], a[252:255], v[48:51], v[188:191]
    ds_read_b128 a[220:223], v10 offset:0
    v_cvt_pk_bf16_f32 v36, v36, v37
    v_mfma_f32_16x16x32_bf16 v[192:195], a[252:255], v[52:55], v[192:195]
    ds_read_b128 a[224:227], v7 offset:1024
    v_cvt_pk_bf16_f32 v37, v38, v39
    v_mfma_f32_16x16x32_bf16 v[196:199], a[252:255], v[56:59], v[196:199]
    v_exp_f32 v79, v79
    v_mfma_f32_16x16x32_bf16 v[200:203], a[252:255], v[60:63], v[200:203]
    s_waitcnt lgkmcnt(3)
    ds_read_b128 a[228:231], v8 offset:1024
    v_cvt_pk_bf16_f32 v38, v76, v77
    v_mfma_f32_16x16x32_bf16 v[124:127], a[20:23], a[0:3], v[124:127]
    ds_read_b128 a[232:235], v9 offset:1024
    v_cvt_pk_bf16_f32 v39, v78, v79
    v_mfma_f32_16x16x32_bf16 v[128:131], a[20:23], a[4:7], v[128:131]
    v_exp_f32 v40, v40
    v_mfma_f32_16x16x32_bf16 v[132:135], a[20:23], a[8:11], v[132:135]
    v_exp_f32 v41, v41
    v_mfma_f32_16x16x32_bf16 v[136:139], a[20:23], a[12:15], v[136:139]
    buffer_load_dwordx4 v3, s[28:31], s58 offen offset:2048 nt lds
    v_mfma_f32_16x16x32_bf16 v[140:143], a[20:23], a[16:19], v[140:143]
    ds_read_b128 a[236:239], v10 offset:1024
    v_mfma_f32_16x16x32_bf16 v[144:147], a[24:27], a[0:3], v[144:147]
    v_mfma_f32_16x16x32_bf16 v[148:151], a[24:27], a[4:7], v[148:151]
    v_exp_f32 v42, v42
    v_mfma_f32_16x16x32_bf16 v[152:155], a[24:27], a[8:11], v[152:155]
    ds_write_b128 v5, v[36:39] offset:3072
    v_mfma_f32_16x16x32_bf16 v[156:159], a[24:27], a[12:15], v[156:159]
    v_exp_f32 v43, v43
    v_mfma_f32_16x16x32_bf16 v[160:163], a[24:27], a[16:19], v[160:163]
    s_waitcnt lgkmcnt(5)
    v_exp_f32 v80, v80
    v_mfma_f32_16x16x32_bf16 v[44:47], a[208:211], v[84:87], v[204:207]
    v_exp_f32 v81, v81
    v_mfma_f32_16x16x32_bf16 v[44:47], a[212:215], v[104:107], v[44:47]
    v_exp_f32 v82, v82
    v_mfma_f32_16x16x32_bf16 v[44:47], a[216:219], a[40:43], v[44:47]
    buffer_load_dwordx4 v3, s[28:31], s58 offen offset:3072 nt lds
    v_mfma_f32_16x16x32_bf16 v[44:47], a[220:223], a[60:63], v[44:47]
    s_waitcnt lgkmcnt(1)
    ds_read_b64_tr_b16 a[28:29], v17 offset:16384
    v_cvt_pk_bf16_f32 v40, v40, v41
    v_mfma_f32_16x16x32_bf16 v[64:67], a[224:227], v[84:87], v[204:207]
    ds_read_b64_tr_b16 a[30:31], v17 offset:17408
    v_cvt_pk_bf16_f32 v41, v42, v43
    v_mfma_f32_16x16x32_bf16 v[64:67], a[228:231], v[104:107], v[64:67]
    v_exp_f32 v83, v83
    v_mfma_f32_16x16x32_bf16 v[64:67], a[232:235], a[40:43], v[64:67]
    ds_read_b64_tr_b16 a[32:33], v18 offset:16384
    v_cvt_pk_bf16_f32 v42, v80, v81
    v_mfma_f32_16x16x32_bf16 v[64:67], a[236:239], a[60:63], v[64:67]
    ds_read_b64_tr_b16 a[34:35], v18 offset:17408
    v_cvt_pk_bf16_f32 v43, v82, v83
    v_mfma_f32_16x16x32_bf16 v[48:51], a[208:211], v[88:91], v[208:211]
    v_exp_f32 v44, v44
    v_mfma_f32_16x16x32_bf16 v[48:51], a[212:215], v[108:111], v[48:51]
    v_exp_f32 v45, v45
    v_mfma_f32_16x16x32_bf16 v[48:51], a[216:219], a[44:47], v[48:51]
    v_mfma_f32_16x16x32_bf16 v[48:51], a[220:223], a[64:67], v[48:51]
    v_mfma_f32_16x16x32_bf16 v[68:71], a[224:227], v[88:91], v[208:211]
    v_mfma_f32_16x16x32_bf16 v[68:71], a[228:231], v[108:111], v[68:71]
    v_exp_f32 v46, v46
    v_mfma_f32_16x16x32_bf16 v[68:71], a[232:235], a[44:47], v[68:71]
    ds_write_b128 v5, v[40:43] offset:4096
    v_mfma_f32_16x16x32_bf16 v[68:71], a[236:239], a[64:67], v[68:71]
    s_waitcnt lgkmcnt(3)
    v_exp_f32 v47, v47
    v_mfma_f32_16x16x32_bf16 v[164:167], a[28:31], a[0:3], v[164:167]
    v_exp_f32 v64, v64
    v_mfma_f32_16x16x32_bf16 v[168:171], a[28:31], a[4:7], v[168:171]
    v_exp_f32 v65, v65
    v_mfma_f32_16x16x32_bf16 v[172:175], a[28:31], a[8:11], v[172:175]
    v_exp_f32 v66, v66
    v_mfma_f32_16x16x32_bf16 v[176:179], a[28:31], a[12:15], v[176:179]
    v_mfma_f32_16x16x32_bf16 v[180:183], a[28:31], a[16:19], v[180:183]
    s_waitcnt lgkmcnt(1)
    v_cvt_pk_bf16_f32 v44, v44, v45
    v_mfma_f32_16x16x32_bf16 v[184:187], a[32:35], a[0:3], v[184:187]
    v_cvt_pk_bf16_f32 v45, v46, v47
    v_mfma_f32_16x16x32_bf16 v[188:191], a[32:35], a[4:7], v[188:191]
    v_exp_f32 v67, v67
    v_mfma_f32_16x16x32_bf16 v[192:195], a[32:35], a[8:11], v[192:195]
    v_cvt_pk_bf16_f32 v46, v64, v65
    v_mfma_f32_16x16x32_bf16 v[196:199], a[32:35], a[12:15], v[196:199]
    v_cvt_pk_bf16_f32 v47, v66, v67
    v_mfma_f32_16x16x32_bf16 v[200:203], a[32:35], a[16:19], v[200:203]
    s_waitcnt vmcnt(8) lgkmcnt(0)
    s_barrier
    v_exp_f32 v48, v48
    v_mfma_f32_16x16x32_bf16 v[52:55], a[208:211], v[92:95], v[212:215]
    s_add_u32 m0, s61, 0
    v_exp_f32 v49, v49
    v_mfma_f32_16x16x32_bf16 v[52:55], a[212:215], v[112:115], v[52:55]
    s_mov_b32 s58, 98304
    buffer_load_dwordx4 v2, s[24:27], s58 offen offset:0 nt lds
    v_mfma_f32_16x16x32_bf16 v[52:55], a[216:219], a[48:51], v[52:55]
    ds_read_b64_tr_b16 a[240:241], v11 offset:32768
    ds_read_b64_tr_b16 a[242:243], v11 offset:33792
    v_mfma_f32_16x16x32_bf16 v[52:55], a[220:223], a[68:71], v[52:55]
    ds_read_b64_tr_b16 a[244:245], v12 offset:32768
    ds_read_b64_tr_b16 a[246:247], v12 offset:33792
    v_mfma_f32_16x16x32_bf16 v[72:75], a[224:227], v[92:95], v[212:215]
    v_exp_f32 v50, v50
    v_mfma_f32_16x16x32_bf16 v[72:75], a[228:231], v[112:115], v[72:75]
    ds_write_b128 v5, v[44:47] offset:5120
    v_mfma_f32_16x16x32_bf16 v[72:75], a[232:235], a[48:51], v[72:75]
    v_exp_f32 v51, v51
    v_mfma_f32_16x16x32_bf16 v[72:75], a[236:239], a[68:71], v[72:75]
    v_exp_f32 v68, v68
    v_mfma_f32_16x16x32_bf16 v[56:59], a[208:211], v[96:99], v[216:219]
    v_exp_f32 v69, v69
    v_mfma_f32_16x16x32_bf16 v[56:59], a[212:215], v[116:119], v[56:59]
    v_exp_f32 v70, v70
    v_mfma_f32_16x16x32_bf16 v[56:59], a[216:219], a[52:55], v[56:59]
    buffer_load_dwordx4 v2, s[24:27], s58 offen offset:1024 nt lds
    v_mfma_f32_16x16x32_bf16 v[56:59], a[220:223], a[72:75], v[56:59]
    ds_read_b128 a[0:3], v6 offset:0
    v_cvt_pk_bf16_f32 v48, v48, v49
    v_mfma_f32_16x16x32_bf16 v[76:79], a[224:227], v[96:99], v[216:219]
    ds_read_b128 a[4:7], v6 offset:1024
    v_cvt_pk_bf16_f32 v49, v50, v51
    v_mfma_f32_16x16x32_bf16 v[76:79], a[228:231], v[116:119], v[76:79]
    v_exp_f32 v71, v71
    v_mfma_f32_16x16x32_bf16 v[76:79], a[232:235], a[52:55], v[76:79]
    ds_read_b128 a[8:11], v6 offset:2048
    v_cvt_pk_bf16_f32 v50, v68, v69
    v_mfma_f32_16x16x32_bf16 v[76:79], a[236:239], a[72:75], v[76:79]
    ds_read_b128 a[12:15], v6 offset:3072
    v_cvt_pk_bf16_f32 v51, v70, v71
    v_mfma_f32_16x16x32_bf16 v[60:63], a[208:211], v[100:103], v[220:223]
    v_exp_f32 v52, v52
    v_mfma_f32_16x16x32_bf16 v[60:63], a[212:215], v[120:123], v[60:63]
    v_exp_f32 v53, v53
    v_mfma_f32_16x16x32_bf16 v[60:63], a[216:219], a[56:59], v[60:63]
    buffer_load_dwordx4 v2, s[24:27], s58 offen offset:2048 nt lds
    v_mfma_f32_16x16x32_bf16 v[60:63], a[220:223], a[76:79], v[60:63]
    ds_read_b64_tr_b16 a[248:249], v13 offset:32768
    ds_read_b64_tr_b16 a[250:251], v13 offset:33792
    v_mfma_f32_16x16x32_bf16 v[80:83], a[224:227], v[100:103], v[220:223]
    ds_read_b64_tr_b16 a[252:253], v14 offset:32768
    ds_read_b64_tr_b16 a[254:255], v14 offset:33792
    v_mfma_f32_16x16x32_bf16 v[80:83], a[228:231], v[120:123], v[80:83]
    v_exp_f32 v54, v54
    v_mfma_f32_16x16x32_bf16 v[80:83], a[232:235], a[56:59], v[80:83]
    ds_write_b128 v5, v[48:51] offset:6144
    v_mfma_f32_16x16x32_bf16 v[80:83], a[236:239], a[76:79], v[80:83]
    v_exp_f32 v55, v55
    v_mfma_f32_16x16x32_bf16 v[224:227], a[36:39], v[24:27], v[224:227]
    v_exp_f32 v72, v72
    v_mfma_f32_16x16x32_bf16 v[228:231], a[36:39], v[28:31], v[228:231]
    v_exp_f32 v73, v73
    v_mfma_f32_16x16x32_bf16 v[232:235], a[36:39], v[32:35], v[232:235]
    v_exp_f32 v74, v74
    v_mfma_f32_16x16x32_bf16 v[236:239], a[36:39], v[36:39], v[236:239]
    buffer_load_dwordx4 v2, s[24:27], s58 offen offset:3072 nt lds
    v_mfma_f32_16x16x32_bf16 v[240:243], a[36:39], v[40:43], v[240:243]
    s_waitcnt lgkmcnt(12)
    ds_read_b128 a[16:19], v6 offset:4096
    v_cvt_pk_bf16_f32 v52, v52, v53
    v_mfma_f32_16x16x32_bf16 v[124:127], a[240:243], v[24:27], v[124:127]
    ds_read_b128 a[208:211], v7 offset:16384
    v_cvt_pk_bf16_f32 v53, v54, v55
    v_mfma_f32_16x16x32_bf16 v[128:131], a[240:243], v[28:31], v[128:131]
    v_exp_f32 v75, v75
    v_mfma_f32_16x16x32_bf16 v[132:135], a[240:243], v[32:35], v[132:135]
    ds_read_b128 a[212:215], v8 offset:16384
    v_cvt_pk_bf16_f32 v54, v72, v73
    v_mfma_f32_16x16x32_bf16 v[136:139], a[240:243], v[36:39], v[136:139]
    ds_read_b128 a[216:219], v9 offset:16384
    v_cvt_pk_bf16_f32 v55, v74, v75
    v_mfma_f32_16x16x32_bf16 v[140:143], a[240:243], v[40:43], v[140:143]
    s_waitcnt lgkmcnt(14)
    v_exp_f32 v56, v56
    v_mfma_f32_16x16x32_bf16 v[144:147], a[244:247], v[24:27], v[144:147]
    s_add_u32 m0, s61, 65536
    v_exp_f32 v57, v57
    v_mfma_f32_16x16x32_bf16 v[148:151], a[244:247], v[28:31], v[148:151]
    s_mov_b32 s58, 81920
    buffer_load_dwordx4 v3, s[28:31], s58 offen offset:0 nt lds
    v_mfma_f32_16x16x32_bf16 v[152:155], a[244:247], v[32:35], v[152:155]
    ds_read_b64_tr_b16 a[20:21], v15 offset:32768
    ds_read_b64_tr_b16 a[22:23], v15 offset:33792
    v_mfma_f32_16x16x32_bf16 v[156:159], a[244:247], v[36:39], v[156:159]
    ds_read_b64_tr_b16 a[24:25], v16 offset:32768
    ds_read_b64_tr_b16 a[26:27], v16 offset:33792
    v_mfma_f32_16x16x32_bf16 v[160:163], a[244:247], v[40:43], v[160:163]
    s_waitcnt lgkmcnt(9)
    v_exp_f32 v58, v58
    v_mfma_f32_16x16x32_bf16 v[164:167], a[248:251], v[24:27], v[164:167]
    ds_write_b128 v5, v[52:55] offset:7168
    v_mfma_f32_16x16x32_bf16 v[168:171], a[248:251], v[28:31], v[168:171]
    v_exp_f32 v59, v59
    v_mfma_f32_16x16x32_bf16 v[172:175], a[248:251], v[32:35], v[172:175]
    v_exp_f32 v76, v76
    v_mfma_f32_16x16x32_bf16 v[176:179], a[248:251], v[36:39], v[176:179]
    v_exp_f32 v77, v77
    v_mfma_f32_16x16x32_bf16 v[180:183], a[248:251], v[40:43], v[180:183]
    v_exp_f32 v78, v78
    v_mfma_f32_16x16x32_bf16 v[184:187], a[252:255], v[24:27], v[184:187]
    buffer_load_dwordx4 v3, s[28:31], s58 offen offset:1024 nt lds
    v_mfma_f32_16x16x32_bf16 v[188:191], a[252:255], v[28:31], v[188:191]
    ds_read_b128 a[220:223], v10 offset:16384
    v_cvt_pk_bf16_f32 v56, v56, v57
    v_mfma_f32_16x16x32_bf16 v[192:195], a[252:255], v[32:35], v[192:195]
    ds_read_b128 a[224:227], v7 offset:17408
    v_cvt_pk_bf16_f32 v57, v58, v59
    v_mfma_f32_16x16x32_bf16 v[196:199], a[252:255], v[36:39], v[196:199]
    v_exp_f32 v79, v79
    v_mfma_f32_16x16x32_bf16 v[200:203], a[252:255], v[40:43], v[200:203]
    s_waitcnt lgkmcnt(3)
    ds_read_b128 a[228:231], v8 offset:17408
    v_cvt_pk_bf16_f32 v58, v76, v77
    v_mfma_f32_16x16x32_bf16 v[124:127], a[20:23], a[0:3], v[124:127]
    ds_read_b128 a[232:235], v9 offset:17408
    v_cvt_pk_bf16_f32 v59, v78, v79
    v_mfma_f32_16x16x32_bf16 v[128:131], a[20:23], a[4:7], v[128:131]
    v_exp_f32 v60, v60
    v_mfma_f32_16x16x32_bf16 v[132:135], a[20:23], a[8:11], v[132:135]
    v_exp_f32 v61, v61
    v_mfma_f32_16x16x32_bf16 v[136:139], a[20:23], a[12:15], v[136:139]
    buffer_load_dwordx4 v3, s[28:31], s58 offen offset:2048 nt lds
    v_mfma_f32_16x16x32_bf16 v[140:143], a[20:23], a[16:19], v[140:143]
    ds_read_b128 a[236:239], v10 offset:17408
    v_mfma_f32_16x16x32_bf16 v[144:147], a[24:27], a[0:3], v[144:147]
    v_mfma_f32_16x16x32_bf16 v[148:151], a[24:27], a[4:7], v[148:151]
    v_exp_f32 v62, v62
    v_mfma_f32_16x16x32_bf16 v[152:155], a[24:27], a[8:11], v[152:155]
    ds_write_b128 v5, v[56:59] offset:8192
    v_mfma_f32_16x16x32_bf16 v[156:159], a[24:27], a[12:15], v[156:159]
    v_exp_f32 v63, v63
    v_mfma_f32_16x16x32_bf16 v[160:163], a[24:27], a[16:19], v[160:163]
    s_waitcnt lgkmcnt(5)
    v_exp_f32 v80, v80
    v_mfma_f32_16x16x32_bf16 v[24:27], a[208:211], v[84:87], v[204:207]
    v_exp_f32 v81, v81
    v_mfma_f32_16x16x32_bf16 v[24:27], a[212:215], v[104:107], v[24:27]
    v_exp_f32 v82, v82
    v_mfma_f32_16x16x32_bf16 v[24:27], a[216:219], a[40:43], v[24:27]
    buffer_load_dwordx4 v3, s[28:31], s58 offen offset:3072 nt lds
    v_mfma_f32_16x16x32_bf16 v[24:27], a[220:223], a[60:63], v[24:27]
    s_waitcnt lgkmcnt(1)
    ds_read_b64_tr_b16 a[28:29], v17 offset:32768
    v_cvt_pk_bf16_f32 v60, v60, v61
    v_mfma_f32_16x16x32_bf16 v[64:67], a[224:227], v[84:87], v[204:207]
    ds_read_b64_tr_b16 a[30:31], v17 offset:33792
    v_cvt_pk_bf16_f32 v61, v62, v63
    v_mfma_f32_16x16x32_bf16 v[64:67], a[228:231], v[104:107], v[64:67]
    v_exp_f32 v83, v83
    v_mfma_f32_16x16x32_bf16 v[64:67], a[232:235], a[40:43], v[64:67]
    ds_read_b64_tr_b16 a[32:33], v18 offset:32768
    v_cvt_pk_bf16_f32 v62, v80, v81
    v_mfma_f32_16x16x32_bf16 v[64:67], a[236:239], a[60:63], v[64:67]
    ds_read_b64_tr_b16 a[34:35], v18 offset:33792
    v_cvt_pk_bf16_f32 v63, v82, v83
    v_mfma_f32_16x16x32_bf16 v[28:31], a[208:211], v[88:91], v[208:211]
    v_exp_f32 v24, v24
    v_mfma_f32_16x16x32_bf16 v[28:31], a[212:215], v[108:111], v[28:31]
    v_exp_f32 v25, v25
    v_mfma_f32_16x16x32_bf16 v[28:31], a[216:219], a[44:47], v[28:31]
    v_and_b32 v248, 3, v1
    v_lshlrev_b32 v248, 7, v248
    v_mfma_f32_16x16x32_bf16 v[28:31], a[220:223], a[64:67], v[28:31]
    buffer_load_dword v252, v248, s[48:51], s34 offen sc1
    v_mfma_f32_16x16x32_bf16 v[68:71], a[224:227], v[88:91], v[208:211]
    v_mfma_f32_16x16x32_bf16 v[68:71], a[228:231], v[108:111], v[68:71]
    v_exp_f32 v26, v26
    v_mfma_f32_16x16x32_bf16 v[68:71], a[232:235], a[44:47], v[68:71]
    ds_write_b128 v5, v[60:63] offset:9216
    v_mfma_f32_16x16x32_bf16 v[68:71], a[236:239], a[64:67], v[68:71]
    s_waitcnt lgkmcnt(3)
    v_exp_f32 v27, v27
    v_mfma_f32_16x16x32_bf16 v[164:167], a[28:31], a[0:3], v[164:167]
    v_exp_f32 v64, v64
    v_mfma_f32_16x16x32_bf16 v[168:171], a[28:31], a[4:7], v[168:171]
    v_exp_f32 v65, v65
    v_mfma_f32_16x16x32_bf16 v[172:175], a[28:31], a[8:11], v[172:175]
    v_exp_f32 v66, v66
    v_mfma_f32_16x16x32_bf16 v[176:179], a[28:31], a[12:15], v[176:179]
    v_mfma_f32_16x16x32_bf16 v[180:183], a[28:31], a[16:19], v[180:183]
    s_waitcnt lgkmcnt(1)
    v_cvt_pk_bf16_f32 v24, v24, v25
    v_mfma_f32_16x16x32_bf16 v[184:187], a[32:35], a[0:3], v[184:187]
    v_cvt_pk_bf16_f32 v25, v26, v27
    v_mfma_f32_16x16x32_bf16 v[188:191], a[32:35], a[4:7], v[188:191]
    v_exp_f32 v67, v67
    v_mfma_f32_16x16x32_bf16 v[192:195], a[32:35], a[8:11], v[192:195]
    v_cvt_pk_bf16_f32 v26, v64, v65
    v_mfma_f32_16x16x32_bf16 v[196:199], a[32:35], a[12:15], v[196:199]
    v_cvt_pk_bf16_f32 v27, v66, v67
    v_mfma_f32_16x16x32_bf16 v[200:203], a[32:35], a[16:19], v[200:203]
    s_waitcnt vmcnt(13) lgkmcnt(0)
    s_barrier
    v_exp_f32 v28, v28
    v_mfma_f32_16x16x32_bf16 v[32:35], a[208:211], v[92:95], v[212:215]
    s_add_u32 m0, s61, 16384
    v_exp_f32 v29, v29
    v_mfma_f32_16x16x32_bf16 v[32:35], a[212:215], v[112:115], v[32:35]
    s_mov_b32 s58, 114688
    buffer_load_dwordx4 v2, s[24:27], s58 offen offset:0 nt lds
    v_mfma_f32_16x16x32_bf16 v[32:35], a[216:219], a[48:51], v[32:35]
    ds_read_b64_tr_b16 a[240:241], v11 offset:49152
    ds_read_b64_tr_b16 a[242:243], v11 offset:50176
    v_mfma_f32_16x16x32_bf16 v[32:35], a[220:223], a[68:71], v[32:35]
    ds_read_b64_tr_b16 a[244:245], v12 offset:49152
    ds_read_b64_tr_b16 a[246:247], v12 offset:50176
    v_mfma_f32_16x16x32_bf16 v[72:75], a[224:227], v[92:95], v[212:215]
    v_exp_f32 v30, v30
    v_mfma_f32_16x16x32_bf16 v[72:75], a[228:231], v[112:115], v[72:75]
    ds_write_b128 v5, v[24:27] offset:0
    v_mfma_f32_16x16x32_bf16 v[72:75], a[232:235], a[48:51], v[72:75]
    v_exp_f32 v31, v31
    v_mfma_f32_16x16x32_bf16 v[72:75], a[236:239], a[68:71], v[72:75]
    v_exp_f32 v68, v68
    v_mfma_f32_16x16x32_bf16 v[36:39], a[208:211], v[96:99], v[216:219]
    v_exp_f32 v69, v69
    v_mfma_f32_16x16x32_bf16 v[36:39], a[212:215], v[116:119], v[36:39]
    v_exp_f32 v70, v70
    v_mfma_f32_16x16x32_bf16 v[36:39], a[216:219], a[52:55], v[36:39]
    buffer_load_dwordx4 v2, s[24:27], s58 offen offset:1024 nt lds
    v_mfma_f32_16x16x32_bf16 v[36:39], a[220:223], a[72:75], v[36:39]
    ds_read_b128 a[0:3], v6 offset:5120
    v_cvt_pk_bf16_f32 v28, v28, v29
    v_mfma_f32_16x16x32_bf16 v[76:79], a[224:227], v[96:99], v[216:219]
    ds_read_b128 a[4:7], v6 offset:6144
    v_cvt_pk_bf16_f32 v29, v30, v31
    v_mfma_f32_16x16x32_bf16 v[76:79], a[228:231], v[116:119], v[76:79]
    v_exp_f32 v71, v71
    v_mfma_f32_16x16x32_bf16 v[76:79], a[232:235], a[52:55], v[76:79]
    ds_read_b128 a[8:11], v6 offset:7168
    v_cvt_pk_bf16_f32 v30, v68, v69
    v_mfma_f32_16x16x32_bf16 v[76:79], a[236:239], a[72:75], v[76:79]
    ds_read_b128 a[12:15], v6 offset:8192
    v_cvt_pk_bf16_f32 v31, v70, v71
    v_mfma_f32_16x16x32_bf16 v[40:43], a[208:211], v[100:103], v[220:223]
    v_exp_f32 v32, v32
    v_mfma_f32_16x16x32_bf16 v[40:43], a[212:215], v[120:123], v[40:43]
    v_exp_f32 v33, v33
    v_mfma_f32_16x16x32_bf16 v[40:43], a[216:219], a[56:59], v[40:43]
    buffer_load_dwordx4 v2, s[24:27], s58 offen offset:2048 nt lds
    v_mfma_f32_16x16x32_bf16 v[40:43], a[220:223], a[76:79], v[40:43]
    ds_read_b64_tr_b16 a[248:249], v13 offset:49152
    ds_read_b64_tr_b16 a[250:251], v13 offset:50176
    v_mfma_f32_16x16x32_bf16 v[80:83], a[224:227], v[100:103], v[220:223]
    ds_read_b64_tr_b16 a[252:253], v14 offset:49152
    ds_read_b64_tr_b16 a[254:255], v14 offset:50176
    v_mfma_f32_16x16x32_bf16 v[80:83], a[228:231], v[120:123], v[80:83]
    v_exp_f32 v34, v34
    v_mfma_f32_16x16x32_bf16 v[80:83], a[232:235], a[56:59], v[80:83]
    ds_write_b128 v5, v[28:31] offset:1024
    v_mfma_f32_16x16x32_bf16 v[80:83], a[236:239], a[76:79], v[80:83]
    v_exp_f32 v35, v35
    v_mfma_f32_16x16x32_bf16 v[224:227], a[36:39], v[44:47], v[224:227]
    v_exp_f32 v72, v72
    v_mfma_f32_16x16x32_bf16 v[228:231], a[36:39], v[48:51], v[228:231]
    v_exp_f32 v73, v73
    v_mfma_f32_16x16x32_bf16 v[232:235], a[36:39], v[52:55], v[232:235]
    v_exp_f32 v74, v74
    v_mfma_f32_16x16x32_bf16 v[236:239], a[36:39], v[56:59], v[236:239]
    buffer_load_dwordx4 v2, s[24:27], s58 offen offset:3072 nt lds
    v_mfma_f32_16x16x32_bf16 v[240:243], a[36:39], v[60:63], v[240:243]
    s_waitcnt lgkmcnt(12)
    ds_read_b128 a[16:19], v6 offset:9216
    v_cvt_pk_bf16_f32 v32, v32, v33
    v_mfma_f32_16x16x32_bf16 v[124:127], a[240:243], v[44:47], v[124:127]
    ds_read_b128 a[208:211], v7 offset:32768
    v_cvt_pk_bf16_f32 v33, v34, v35
    v_mfma_f32_16x16x32_bf16 v[128:131], a[240:243], v[48:51], v[128:131]
    v_exp_f32 v75, v75
    v_mfma_f32_16x16x32_bf16 v[132:135], a[240:243], v[52:55], v[132:135]
    ds_read_b128 a[212:215], v8 offset:32768
    v_cvt_pk_bf16_f32 v34, v72, v73
    v_mfma_f32_16x16x32_bf16 v[136:139], a[240:243], v[56:59], v[136:139]
    ds_read_b128 a[216:219], v9 offset:32768
    v_cvt_pk_bf16_f32 v35, v74, v75
    v_mfma_f32_16x16x32_bf16 v[140:143], a[240:243], v[60:63], v[140:143]
    s_waitcnt lgkmcnt(14)
    v_exp_f32 v36, v36
    v_mfma_f32_16x16x32_bf16 v[144:147], a[244:247], v[44:47], v[144:147]
    s_add_u32 m0, s61, 81920
    v_exp_f32 v37, v37
    v_mfma_f32_16x16x32_bf16 v[148:151], a[244:247], v[48:51], v[148:151]
    s_mov_b32 s58, 98304
    buffer_load_dwordx4 v3, s[28:31], s58 offen offset:0 nt lds
    v_mfma_f32_16x16x32_bf16 v[152:155], a[244:247], v[52:55], v[152:155]
    ds_read_b64_tr_b16 a[20:21], v15 offset:49152
    ds_read_b64_tr_b16 a[22:23], v15 offset:50176
    v_mfma_f32_16x16x32_bf16 v[156:159], a[244:247], v[56:59], v[156:159]
    ds_read_b64_tr_b16 a[24:25], v16 offset:49152
    ds_read_b64_tr_b16 a[26:27], v16 offset:50176
    v_mfma_f32_16x16x32_bf16 v[160:163], a[244:247], v[60:63], v[160:163]
    s_waitcnt lgkmcnt(9)
    v_exp_f32 v38, v38
    v_mfma_f32_16x16x32_bf16 v[164:167], a[248:251], v[44:47], v[164:167]
    ds_write_b128 v5, v[32:35] offset:2048
    v_mfma_f32_16x16x32_bf16 v[168:171], a[248:251], v[48:51], v[168:171]
    v_exp_f32 v39, v39
    v_mfma_f32_16x16x32_bf16 v[172:175], a[248:251], v[52:55], v[172:175]
    v_exp_f32 v76, v76
    v_mfma_f32_16x16x32_bf16 v[176:179], a[248:251], v[56:59], v[176:179]
    v_exp_f32 v77, v77
    v_mfma_f32_16x16x32_bf16 v[180:183], a[248:251], v[60:63], v[180:183]
    v_exp_f32 v78, v78
    v_mfma_f32_16x16x32_bf16 v[184:187], a[252:255], v[44:47], v[184:187]
    buffer_load_dwordx4 v3, s[28:31], s58 offen offset:1024 nt lds
    v_mfma_f32_16x16x32_bf16 v[188:191], a[252:255], v[48:51], v[188:191]
    ds_read_b128 a[220:223], v10 offset:32768
    v_cvt_pk_bf16_f32 v36, v36, v37
    v_mfma_f32_16x16x32_bf16 v[192:195], a[252:255], v[52:55], v[192:195]
    ds_read_b128 a[224:227], v7 offset:33792
    v_cvt_pk_bf16_f32 v37, v38, v39
    v_mfma_f32_16x16x32_bf16 v[196:199], a[252:255], v[56:59], v[196:199]
    v_exp_f32 v79, v79
    v_mfma_f32_16x16x32_bf16 v[200:203], a[252:255], v[60:63], v[200:203]
    s_waitcnt lgkmcnt(3)
    ds_read_b128 a[228:231], v8 offset:33792
    v_cvt_pk_bf16_f32 v38, v76, v77
    v_mfma_f32_16x16x32_bf16 v[124:127], a[20:23], a[0:3], v[124:127]
    ds_read_b128 a[232:235], v9 offset:33792
    v_cvt_pk_bf16_f32 v39, v78, v79
    v_mfma_f32_16x16x32_bf16 v[128:131], a[20:23], a[4:7], v[128:131]
    v_exp_f32 v40, v40
    v_mfma_f32_16x16x32_bf16 v[132:135], a[20:23], a[8:11], v[132:135]
    v_exp_f32 v41, v41
    v_mfma_f32_16x16x32_bf16 v[136:139], a[20:23], a[12:15], v[136:139]
    buffer_load_dwordx4 v3, s[28:31], s58 offen offset:2048 nt lds
    v_mfma_f32_16x16x32_bf16 v[140:143], a[20:23], a[16:19], v[140:143]
    ds_read_b128 a[236:239], v10 offset:33792
    v_mfma_f32_16x16x32_bf16 v[144:147], a[24:27], a[0:3], v[144:147]
    v_mfma_f32_16x16x32_bf16 v[148:151], a[24:27], a[4:7], v[148:151]
    v_exp_f32 v42, v42
    v_mfma_f32_16x16x32_bf16 v[152:155], a[24:27], a[8:11], v[152:155]
    ds_write_b128 v5, v[36:39] offset:3072
    v_mfma_f32_16x16x32_bf16 v[156:159], a[24:27], a[12:15], v[156:159]
    v_exp_f32 v43, v43
    v_mfma_f32_16x16x32_bf16 v[160:163], a[24:27], a[16:19], v[160:163]
    s_waitcnt lgkmcnt(5)
    v_exp_f32 v80, v80
    v_mfma_f32_16x16x32_bf16 v[44:47], a[208:211], v[84:87], v[204:207]
    v_exp_f32 v81, v81
    v_mfma_f32_16x16x32_bf16 v[44:47], a[212:215], v[104:107], v[44:47]
    v_exp_f32 v82, v82
    v_mfma_f32_16x16x32_bf16 v[44:47], a[216:219], a[40:43], v[44:47]
    buffer_load_dwordx4 v3, s[28:31], s58 offen offset:3072 nt lds
    v_mfma_f32_16x16x32_bf16 v[44:47], a[220:223], a[60:63], v[44:47]
    s_waitcnt lgkmcnt(1)
    ds_read_b64_tr_b16 a[28:29], v17 offset:49152
    v_cvt_pk_bf16_f32 v40, v40, v41
    v_mfma_f32_16x16x32_bf16 v[64:67], a[224:227], v[84:87], v[204:207]
    ds_read_b64_tr_b16 a[30:31], v17 offset:50176
    v_cvt_pk_bf16_f32 v41, v42, v43
    v_mfma_f32_16x16x32_bf16 v[64:67], a[228:231], v[104:107], v[64:67]
    v_exp_f32 v83, v83
    v_mfma_f32_16x16x32_bf16 v[64:67], a[232:235], a[40:43], v[64:67]
    ds_read_b64_tr_b16 a[32:33], v18 offset:49152
    v_cvt_pk_bf16_f32 v42, v80, v81
    v_mfma_f32_16x16x32_bf16 v[64:67], a[236:239], a[60:63], v[64:67]
    ds_read_b64_tr_b16 a[34:35], v18 offset:50176
    v_cvt_pk_bf16_f32 v43, v82, v83
    v_mfma_f32_16x16x32_bf16 v[48:51], a[208:211], v[88:91], v[208:211]
    v_exp_f32 v44, v44
    v_mfma_f32_16x16x32_bf16 v[48:51], a[212:215], v[108:111], v[48:51]
    v_exp_f32 v45, v45
    v_mfma_f32_16x16x32_bf16 v[48:51], a[216:219], a[44:47], v[48:51]
    v_mfma_f32_16x16x32_bf16 v[48:51], a[220:223], a[64:67], v[48:51]
    v_mfma_f32_16x16x32_bf16 v[68:71], a[224:227], v[88:91], v[208:211]
    v_mfma_f32_16x16x32_bf16 v[68:71], a[228:231], v[108:111], v[68:71]
    v_exp_f32 v46, v46
    v_mfma_f32_16x16x32_bf16 v[68:71], a[232:235], a[44:47], v[68:71]
    ds_write_b128 v5, v[40:43] offset:4096
    v_mfma_f32_16x16x32_bf16 v[68:71], a[236:239], a[64:67], v[68:71]
    s_waitcnt lgkmcnt(3)
    v_exp_f32 v47, v47
    v_mfma_f32_16x16x32_bf16 v[164:167], a[28:31], a[0:3], v[164:167]
    v_exp_f32 v64, v64
    v_mfma_f32_16x16x32_bf16 v[168:171], a[28:31], a[4:7], v[168:171]
    v_exp_f32 v65, v65
    v_mfma_f32_16x16x32_bf16 v[172:175], a[28:31], a[8:11], v[172:175]
    v_exp_f32 v66, v66
    v_mfma_f32_16x16x32_bf16 v[176:179], a[28:31], a[12:15], v[176:179]
    v_mfma_f32_16x16x32_bf16 v[180:183], a[28:31], a[16:19], v[180:183]
    s_waitcnt lgkmcnt(1)
    v_cvt_pk_bf16_f32 v44, v44, v45
    v_mfma_f32_16x16x32_bf16 v[184:187], a[32:35], a[0:3], v[184:187]
    v_cvt_pk_bf16_f32 v45, v46, v47
    v_mfma_f32_16x16x32_bf16 v[188:191], a[32:35], a[4:7], v[188:191]
    v_exp_f32 v67, v67
    v_mfma_f32_16x16x32_bf16 v[192:195], a[32:35], a[8:11], v[192:195]
    v_cvt_pk_bf16_f32 v46, v64, v65
    v_mfma_f32_16x16x32_bf16 v[196:199], a[32:35], a[12:15], v[196:199]
    v_cvt_pk_bf16_f32 v47, v66, v67
    v_mfma_f32_16x16x32_bf16 v[200:203], a[32:35], a[16:19], v[200:203]
    s_waitcnt vmcnt(13) lgkmcnt(0)
    s_barrier
    v_exp_f32 v48, v48
    v_mfma_f32_16x16x32_bf16 v[52:55], a[208:211], v[92:95], v[212:215]
    s_add_u32 m0, s61, 98304
    v_exp_f32 v49, v49
    v_mfma_f32_16x16x32_bf16 v[52:55], a[212:215], v[112:115], v[52:55]
    s_mov_b32 s58, 114688
    buffer_load_dwordx4 v3, s[28:31], s58 offen offset:0 nt lds
    v_mfma_f32_16x16x32_bf16 v[52:55], a[216:219], a[48:51], v[52:55]
    ds_read_b64_tr_b16 a[240:241], v11 offset:0
    ds_read_b64_tr_b16 a[242:243], v11 offset:1024
    v_mfma_f32_16x16x32_bf16 v[52:55], a[220:223], a[68:71], v[52:55]
    ds_read_b64_tr_b16 a[244:245], v12 offset:0
    ds_read_b64_tr_b16 a[246:247], v12 offset:1024
    v_mfma_f32_16x16x32_bf16 v[72:75], a[224:227], v[92:95], v[212:215]
    v_exp_f32 v50, v50
    v_mfma_f32_16x16x32_bf16 v[72:75], a[228:231], v[112:115], v[72:75]
    ds_write_b128 v5, v[44:47] offset:5120
    v_mfma_f32_16x16x32_bf16 v[72:75], a[232:235], a[48:51], v[72:75]
    v_exp_f32 v51, v51
    v_mfma_f32_16x16x32_bf16 v[72:75], a[236:239], a[68:71], v[72:75]
    v_exp_f32 v68, v68
    v_mfma_f32_16x16x32_bf16 v[56:59], a[208:211], v[96:99], v[216:219]
    v_exp_f32 v69, v69
    v_mfma_f32_16x16x32_bf16 v[56:59], a[212:215], v[116:119], v[56:59]
    v_exp_f32 v70, v70
    v_mfma_f32_16x16x32_bf16 v[56:59], a[216:219], a[52:55], v[56:59]
    buffer_load_dwordx4 v3, s[28:31], s58 offen offset:1024 nt lds
    v_mfma_f32_16x16x32_bf16 v[56:59], a[220:223], a[72:75], v[56:59]
    ds_read_b128 a[0:3], v6 offset:0
    v_cvt_pk_bf16_f32 v48, v48, v49
    v_mfma_f32_16x16x32_bf16 v[76:79], a[224:227], v[96:99], v[216:219]
    ds_read_b128 a[4:7], v6 offset:1024
    v_cvt_pk_bf16_f32 v49, v50, v51
    v_mfma_f32_16x16x32_bf16 v[76:79], a[228:231], v[116:119], v[76:79]
    v_exp_f32 v71, v71
    v_mfma_f32_16x16x32_bf16 v[76:79], a[232:235], a[52:55], v[76:79]
    ds_read_b128 a[8:11], v6 offset:2048
    v_cvt_pk_bf16_f32 v50, v68, v69
    v_mfma_f32_16x16x32_bf16 v[76:79], a[236:239], a[72:75], v[76:79]
    ds_read_b128 a[12:15], v6 offset:3072
    v_cvt_pk_bf16_f32 v51, v70, v71
    v_mfma_f32_16x16x32_bf16 v[60:63], a[208:211], v[100:103], v[220:223]
    v_exp_f32 v52, v52
    v_mfma_f32_16x16x32_bf16 v[60:63], a[212:215], v[120:123], v[60:63]
    v_exp_f32 v53, v53
    v_mfma_f32_16x16x32_bf16 v[60:63], a[216:219], a[56:59], v[60:63]
    buffer_load_dwordx4 v3, s[28:31], s58 offen offset:2048 nt lds
    v_mfma_f32_16x16x32_bf16 v[60:63], a[220:223], a[76:79], v[60:63]
    ds_read_b64_tr_b16 a[248:249], v13 offset:0
    ds_read_b64_tr_b16 a[250:251], v13 offset:1024
    v_mfma_f32_16x16x32_bf16 v[80:83], a[224:227], v[100:103], v[220:223]
    ds_read_b64_tr_b16 a[252:253], v14 offset:0
    ds_read_b64_tr_b16 a[254:255], v14 offset:1024
    v_mfma_f32_16x16x32_bf16 v[80:83], a[228:231], v[120:123], v[80:83]
    v_exp_f32 v54, v54
    v_mfma_f32_16x16x32_bf16 v[80:83], a[232:235], a[56:59], v[80:83]
    ds_write_b128 v5, v[48:51] offset:6144
    v_mfma_f32_16x16x32_bf16 v[80:83], a[236:239], a[76:79], v[80:83]
    v_exp_f32 v55, v55
    v_mfma_f32_16x16x32_bf16 v[224:227], a[36:39], v[24:27], v[224:227]
    v_exp_f32 v72, v72
    v_mfma_f32_16x16x32_bf16 v[228:231], a[36:39], v[28:31], v[228:231]
    v_exp_f32 v73, v73
    v_mfma_f32_16x16x32_bf16 v[232:235], a[36:39], v[32:35], v[232:235]
    v_exp_f32 v74, v74
    v_mfma_f32_16x16x32_bf16 v[236:239], a[36:39], v[36:39], v[236:239]
    buffer_load_dwordx4 v3, s[28:31], s58 offen offset:3072 nt lds
    v_mfma_f32_16x16x32_bf16 v[240:243], a[36:39], v[40:43], v[240:243]
    s_waitcnt lgkmcnt(12)
    ds_read_b128 a[16:19], v6 offset:4096
    v_cvt_pk_bf16_f32 v52, v52, v53
    v_mfma_f32_16x16x32_bf16 v[124:127], a[240:243], v[24:27], v[124:127]
    ds_read_b128 a[208:211], v7 offset:0
    v_cvt_pk_bf16_f32 v53, v54, v55
    v_mfma_f32_16x16x32_bf16 v[128:131], a[240:243], v[28:31], v[128:131]
    v_exp_f32 v75, v75
    v_mfma_f32_16x16x32_bf16 v[132:135], a[240:243], v[32:35], v[132:135]
    ds_read_b128 a[212:215], v8 offset:0
    v_cvt_pk_bf16_f32 v54, v72, v73
    v_mfma_f32_16x16x32_bf16 v[136:139], a[240:243], v[36:39], v[136:139]
    ds_read_b128 a[216:219], v9 offset:0
    v_cvt_pk_bf16_f32 v55, v74, v75
    v_mfma_f32_16x16x32_bf16 v[140:143], a[240:243], v[40:43], v[140:143]
    s_waitcnt lgkmcnt(14)
    v_exp_f32 v56, v56
    v_mfma_f32_16x16x32_bf16 v[144:147], a[244:247], v[24:27], v[144:147]
    s_add_u32 m0, s61, 32768
    v_exp_f32 v57, v57
    v_mfma_f32_16x16x32_bf16 v[148:151], a[244:247], v[28:31], v[148:151]
    s_add_u32 s60, s6, 0
    buffer_load_dwordx4 v4, s[36:39], s60 offen offset:0 lds
    v_mfma_f32_16x16x32_bf16 v[152:155], a[244:247], v[32:35], v[152:155]
    ds_read_b64_tr_b16 a[20:21], v15 offset:0
    ds_read_b64_tr_b16 a[22:23], v15 offset:1024
    v_mfma_f32_16x16x32_bf16 v[156:159], a[244:247], v[36:39], v[156:159]
    ds_read_b64_tr_b16 a[24:25], v16 offset:0
    ds_read_b64_tr_b16 a[26:27], v16 offset:1024
    v_mfma_f32_16x16x32_bf16 v[160:163], a[244:247], v[40:43], v[160:163]
    s_waitcnt lgkmcnt(9)
    v_exp_f32 v58, v58
    v_mfma_f32_16x16x32_bf16 v[164:167], a[248:251], v[24:27], v[164:167]
    ds_write_b128 v5, v[52:55] offset:7168
    v_mfma_f32_16x16x32_bf16 v[168:171], a[248:251], v[28:31], v[168:171]
    v_exp_f32 v59, v59
    v_mfma_f32_16x16x32_bf16 v[172:175], a[248:251], v[32:35], v[172:175]
    v_exp_f32 v76, v76
    v_mfma_f32_16x16x32_bf16 v[176:179], a[248:251], v[36:39], v[176:179]
    v_exp_f32 v77, v77
    v_mfma_f32_16x16x32_bf16 v[180:183], a[248:251], v[40:43], v[180:183]
    v_exp_f32 v78, v78
    v_mfma_f32_16x16x32_bf16 v[184:187], a[252:255], v[24:27], v[184:187]
    s_add_u32 s60, s6, 3072
    buffer_load_dwordx4 v255, s[36:39], s60 offen offset:1024 lds
    v_mfma_f32_16x16x32_bf16 v[188:191], a[252:255], v[28:31], v[188:191]
    ds_read_b128 a[220:223], v10 offset:0
    v_cvt_pk_bf16_f32 v56, v56, v57
    v_mfma_f32_16x16x32_bf16 v[192:195], a[252:255], v[32:35], v[192:195]
    ds_read_b128 a[224:227], v7 offset:1024
    v_cvt_pk_bf16_f32 v57, v58, v59
    v_mfma_f32_16x16x32_bf16 v[196:199], a[252:255], v[36:39], v[196:199]
    v_exp_f32 v79, v79
    v_mfma_f32_16x16x32_bf16 v[200:203], a[252:255], v[40:43], v[200:203]
    s_waitcnt lgkmcnt(3)
    ds_read_b128 a[228:231], v8 offset:1024
    v_cvt_pk_bf16_f32 v58, v76, v77
    v_mfma_f32_16x16x32_bf16 v[124:127], a[20:23], a[0:3], v[124:127]
    ds_read_b128 a[232:235], v9 offset:1024
    v_cvt_pk_bf16_f32 v59, v78, v79
    v_mfma_f32_16x16x32_bf16 v[128:131], a[20:23], a[4:7], v[128:131]
    v_exp_f32 v60, v60
    v_mfma_f32_16x16x32_bf16 v[132:135], a[20:23], a[8:11], v[132:135]
    v_exp_f32 v61, v61
    v_mfma_f32_16x16x32_bf16 v[136:139], a[20:23], a[12:15], v[136:139]
    s_add_u32 s60, s6, 6144
    buffer_load_dwordx4 v4, s[36:39], s60 offen offset:2048 lds
    v_mfma_f32_16x16x32_bf16 v[140:143], a[20:23], a[16:19], v[140:143]
    ds_read_b128 a[236:239], v10 offset:1024
    v_mfma_f32_16x16x32_bf16 v[144:147], a[24:27], a[0:3], v[144:147]
    v_mfma_f32_16x16x32_bf16 v[148:151], a[24:27], a[4:7], v[148:151]
    v_exp_f32 v62, v62
    v_mfma_f32_16x16x32_bf16 v[152:155], a[24:27], a[8:11], v[152:155]
    ds_write_b128 v5, v[56:59] offset:8192
    v_mfma_f32_16x16x32_bf16 v[156:159], a[24:27], a[12:15], v[156:159]
    v_exp_f32 v63, v63
    v_mfma_f32_16x16x32_bf16 v[160:163], a[24:27], a[16:19], v[160:163]
    s_waitcnt lgkmcnt(5)
    v_exp_f32 v80, v80
    v_mfma_f32_16x16x32_bf16 v[24:27], a[208:211], v[84:87], v[204:207]
    v_exp_f32 v81, v81
    v_mfma_f32_16x16x32_bf16 v[24:27], a[212:215], v[104:107], v[24:27]
    v_exp_f32 v82, v82
    v_mfma_f32_16x16x32_bf16 v[24:27], a[216:219], a[40:43], v[24:27]
    s_add_u32 s60, s6, 9216
    buffer_load_dwordx4 v255, s[36:39], s60 offen offset:3072 lds
    v_mfma_f32_16x16x32_bf16 v[24:27], a[220:223], a[60:63], v[24:27]
    s_waitcnt lgkmcnt(1)
    ds_read_b64_tr_b16 a[28:29], v17 offset:0
    v_cvt_pk_bf16_f32 v60, v60, v61
    v_mfma_f32_16x16x32_bf16 v[64:67], a[224:227], v[84:87], v[204:207]
    ds_read_b64_tr_b16 a[30:31], v17 offset:1024
    v_cvt_pk_bf16_f32 v61, v62, v63
    v_mfma_f32_16x16x32_bf16 v[64:67], a[228:231], v[104:107], v[64:67]
    v_exp_f32 v83, v83
    v_mfma_f32_16x16x32_bf16 v[64:67], a[232:235], a[40:43], v[64:67]
    ds_read_b64_tr_b16 a[32:33], v18 offset:0
    v_cvt_pk_bf16_f32 v62, v80, v81
    v_mfma_f32_16x16x32_bf16 v[64:67], a[236:239], a[60:63], v[64:67]
    ds_read_b64_tr_b16 a[34:35], v18 offset:1024
    v_cvt_pk_bf16_f32 v63, v82, v83
    v_mfma_f32_16x16x32_bf16 v[28:31], a[208:211], v[88:91], v[208:211]
    v_exp_f32 v24, v24
    v_mfma_f32_16x16x32_bf16 v[28:31], a[212:215], v[108:111], v[28:31]
    v_exp_f32 v25, v25
    v_mfma_f32_16x16x32_bf16 v[28:31], a[216:219], a[44:47], v[28:31]
    v_mfma_f32_16x16x32_bf16 v[28:31], a[220:223], a[64:67], v[28:31]
    v_mfma_f32_16x16x32_bf16 v[68:71], a[224:227], v[88:91], v[208:211]
    v_mfma_f32_16x16x32_bf16 v[68:71], a[228:231], v[108:111], v[68:71]
    v_exp_f32 v26, v26
    v_mfma_f32_16x16x32_bf16 v[68:71], a[232:235], a[44:47], v[68:71]
    ds_write_b128 v5, v[60:63] offset:9216
    v_mfma_f32_16x16x32_bf16 v[68:71], a[236:239], a[64:67], v[68:71]
    s_waitcnt lgkmcnt(3)
    v_exp_f32 v27, v27
    v_mfma_f32_16x16x32_bf16 v[164:167], a[28:31], a[0:3], v[164:167]
    v_exp_f32 v64, v64
    v_mfma_f32_16x16x32_bf16 v[168:171], a[28:31], a[4:7], v[168:171]
    v_exp_f32 v65, v65
    v_mfma_f32_16x16x32_bf16 v[172:175], a[28:31], a[8:11], v[172:175]
    v_exp_f32 v66, v66
    v_mfma_f32_16x16x32_bf16 v[176:179], a[28:31], a[12:15], v[176:179]
    v_mfma_f32_16x16x32_bf16 v[180:183], a[28:31], a[16:19], v[180:183]
    s_waitcnt lgkmcnt(1)
    v_cvt_pk_bf16_f32 v24, v24, v25
    v_mfma_f32_16x16x32_bf16 v[184:187], a[32:35], a[0:3], v[184:187]
    v_cvt_pk_bf16_f32 v25, v26, v27
    v_mfma_f32_16x16x32_bf16 v[188:191], a[32:35], a[4:7], v[188:191]
    v_exp_f32 v67, v67
    v_mfma_f32_16x16x32_bf16 v[192:195], a[32:35], a[8:11], v[192:195]
    v_cvt_pk_bf16_f32 v26, v64, v65
    v_mfma_f32_16x16x32_bf16 v[196:199], a[32:35], a[12:15], v[196:199]
    v_cvt_pk_bf16_f32 v27, v66, v67
    v_mfma_f32_16x16x32_bf16 v[200:203], a[32:35], a[16:19], v[200:203]
    s_waitcnt vmcnt(12) lgkmcnt(0)
    s_barrier
    v_exp_f32 v28, v28
    v_mfma_f32_16x16x32_bf16 v[32:35], a[208:211], v[92:95], v[212:215]
    s_add_u32 m0, s61, 0
    v_exp_f32 v29, v29
    v_mfma_f32_16x16x32_bf16 v[32:35], a[212:215], v[112:115], v[32:35]
    s_add_u32 s60, s6, 65536
    buffer_load_dwordx4 v4, s[36:39], s60 offen offset:0 lds
    v_mfma_f32_16x16x32_bf16 v[32:35], a[216:219], a[48:51], v[32:35]
    ds_read_b64_tr_b16 a[240:241], v11 offset:16384
    ds_read_b64_tr_b16 a[242:243], v11 offset:17408
    v_mfma_f32_16x16x32_bf16 v[32:35], a[220:223], a[68:71], v[32:35]
    ds_read_b64_tr_b16 a[244:245], v12 offset:16384
    ds_read_b64_tr_b16 a[246:247], v12 offset:17408
    v_mfma_f32_16x16x32_bf16 v[72:75], a[224:227], v[92:95], v[212:215]
    v_exp_f32 v30, v30
    v_mfma_f32_16x16x32_bf16 v[72:75], a[228:231], v[112:115], v[72:75]
    ds_write_b128 v5, v[24:27] offset:0
    v_mfma_f32_16x16x32_bf16 v[72:75], a[232:235], a[48:51], v[72:75]
    v_exp_f32 v31, v31
    v_mfma_f32_16x16x32_bf16 v[72:75], a[236:239], a[68:71], v[72:75]
    v_exp_f32 v68, v68
    v_mfma_f32_16x16x32_bf16 v[36:39], a[208:211], v[96:99], v[216:219]
    v_exp_f32 v69, v69
    v_mfma_f32_16x16x32_bf16 v[36:39], a[212:215], v[116:119], v[36:39]
    v_exp_f32 v70, v70
    v_mfma_f32_16x16x32_bf16 v[36:39], a[216:219], a[52:55], v[36:39]
    s_add_u32 s60, s6, 68608
    buffer_load_dwordx4 v255, s[36:39], s60 offen offset:1024 lds
    v_mfma_f32_16x16x32_bf16 v[36:39], a[220:223], a[72:75], v[36:39]
    ds_read_b128 a[0:3], v6 offset:5120
    v_cvt_pk_bf16_f32 v28, v28, v29
    v_mfma_f32_16x16x32_bf16 v[76:79], a[224:227], v[96:99], v[216:219]
    ds_read_b128 a[4:7], v6 offset:6144
    v_cvt_pk_bf16_f32 v29, v30, v31
    v_mfma_f32_16x16x32_bf16 v[76:79], a[228:231], v[116:119], v[76:79]
    v_exp_f32 v71, v71
    v_mfma_f32_16x16x32_bf16 v[76:79], a[232:235], a[52:55], v[76:79]
    ds_read_b128 a[8:11], v6 offset:7168
    v_cvt_pk_bf16_f32 v30, v68, v69
    v_mfma_f32_16x16x32_bf16 v[76:79], a[236:239], a[72:75], v[76:79]
    ds_read_b128 a[12:15], v6 offset:8192
    v_cvt_pk_bf16_f32 v31, v70, v71
    v_mfma_f32_16x16x32_bf16 v[40:43], a[208:211], v[100:103], v[220:223]
    v_exp_f32 v32, v32
    v_mfma_f32_16x16x32_bf16 v[40:43], a[212:215], v[120:123], v[40:43]
    v_exp_f32 v33, v33
    v_mfma_f32_16x16x32_bf16 v[40:43], a[216:219], a[56:59], v[40:43]
    s_add_u32 s60, s6, 71680
    buffer_load_dwordx4 v4, s[36:39], s60 offen offset:2048 lds
    v_mfma_f32_16x16x32_bf16 v[40:43], a[220:223], a[76:79], v[40:43]
    ds_read_b64_tr_b16 a[248:249], v13 offset:16384
    ds_read_b64_tr_b16 a[250:251], v13 offset:17408
    v_mfma_f32_16x16x32_bf16 v[80:83], a[224:227], v[100:103], v[220:223]
    ds_read_b64_tr_b16 a[252:253], v14 offset:16384
    ds_read_b64_tr_b16 a[254:255], v14 offset:17408
    v_mfma_f32_16x16x32_bf16 v[80:83], a[228:231], v[120:123], v[80:83]
    v_exp_f32 v34, v34
    v_mfma_f32_16x16x32_bf16 v[80:83], a[232:235], a[56:59], v[80:83]
    ds_write_b128 v5, v[28:31] offset:1024
    v_mfma_f32_16x16x32_bf16 v[80:83], a[236:239], a[76:79], v[80:83]
    v_exp_f32 v35, v35
    v_mfma_f32_16x16x32_bf16 v[224:227], a[36:39], v[44:47], v[224:227]
    v_exp_f32 v72, v72
    v_mfma_f32_16x16x32_bf16 v[228:231], a[36:39], v[48:51], v[228:231]
    v_exp_f32 v73, v73
    v_mfma_f32_16x16x32_bf16 v[232:235], a[36:39], v[52:55], v[232:235]
    v_exp_f32 v74, v74
    v_mfma_f32_16x16x32_bf16 v[236:239], a[36:39], v[56:59], v[236:239]
    s_add_u32 s60, s6, 74752
    buffer_load_dwordx4 v255, s[36:39], s60 offen offset:3072 lds
    v_mfma_f32_16x16x32_bf16 v[240:243], a[36:39], v[60:63], v[240:243]
    s_waitcnt lgkmcnt(12)
    ds_read_b128 a[16:19], v6 offset:9216
    v_cvt_pk_bf16_f32 v32, v32, v33
    v_mfma_f32_16x16x32_bf16 v[124:127], a[240:243], v[44:47], v[124:127]
    ds_read_b128 a[208:211], v7 offset:16384
    v_cvt_pk_bf16_f32 v33, v34, v35
    v_mfma_f32_16x16x32_bf16 v[128:131], a[240:243], v[48:51], v[128:131]
    v_exp_f32 v75, v75
    v_mfma_f32_16x16x32_bf16 v[132:135], a[240:243], v[52:55], v[132:135]
    ds_read_b128 a[212:215], v8 offset:16384
    v_cvt_pk_bf16_f32 v34, v72, v73
    v_mfma_f32_16x16x32_bf16 v[136:139], a[240:243], v[56:59], v[136:139]
    ds_read_b128 a[216:219], v9 offset:16384
    v_cvt_pk_bf16_f32 v35, v74, v75
    v_mfma_f32_16x16x32_bf16 v[140:143], a[240:243], v[60:63], v[140:143]
    s_waitcnt lgkmcnt(14)
    v_exp_f32 v36, v36
    v_mfma_f32_16x16x32_bf16 v[144:147], a[244:247], v[44:47], v[144:147]
    s_add_u32 m0, s61, 49152
    v_exp_f32 v37, v37
    v_mfma_f32_16x16x32_bf16 v[148:151], a[244:247], v[48:51], v[148:151]
    s_add_u32 s60, s7, 0
    buffer_load_dwordx4 v4, s[36:39], s60 offen offset:0 lds
    v_mfma_f32_16x16x32_bf16 v[152:155], a[244:247], v[52:55], v[152:155]
    ds_read_b64_tr_b16 a[20:21], v15 offset:16384
    ds_read_b64_tr_b16 a[22:23], v15 offset:17408
    v_mfma_f32_16x16x32_bf16 v[156:159], a[244:247], v[56:59], v[156:159]
    ds_read_b64_tr_b16 a[24:25], v16 offset:16384
    ds_read_b64_tr_b16 a[26:27], v16 offset:17408
    v_mfma_f32_16x16x32_bf16 v[160:163], a[244:247], v[60:63], v[160:163]
    s_waitcnt lgkmcnt(9)
    v_exp_f32 v38, v38
    v_mfma_f32_16x16x32_bf16 v[164:167], a[248:251], v[44:47], v[164:167]
    ds_write_b128 v5, v[32:35] offset:2048
    v_mfma_f32_16x16x32_bf16 v[168:171], a[248:251], v[48:51], v[168:171]
    v_exp_f32 v39, v39
    v_mfma_f32_16x16x32_bf16 v[172:175], a[248:251], v[52:55], v[172:175]
    v_exp_f32 v76, v76
    v_mfma_f32_16x16x32_bf16 v[176:179], a[248:251], v[56:59], v[176:179]
    v_exp_f32 v77, v77
    v_mfma_f32_16x16x32_bf16 v[180:183], a[248:251], v[60:63], v[180:183]
    v_exp_f32 v78, v78
    v_mfma_f32_16x16x32_bf16 v[184:187], a[252:255], v[44:47], v[184:187]
    s_add_u32 s60, s7, 3072
    buffer_load_dwordx4 v255, s[36:39], s60 offen offset:1024 lds
    v_mfma_f32_16x16x32_bf16 v[188:191], a[252:255], v[48:51], v[188:191]
    ds_read_b128 a[220:223], v10 offset:16384
    v_cvt_pk_bf16_f32 v36, v36, v37
    v_mfma_f32_16x16x32_bf16 v[192:195], a[252:255], v[52:55], v[192:195]
    ds_read_b128 a[224:227], v7 offset:17408
    v_cvt_pk_bf16_f32 v37, v38, v39
    v_mfma_f32_16x16x32_bf16 v[196:199], a[252:255], v[56:59], v[196:199]
    v_exp_f32 v79, v79
    v_mfma_f32_16x16x32_bf16 v[200:203], a[252:255], v[60:63], v[200:203]
    s_waitcnt lgkmcnt(3)
    ds_read_b128 a[228:231], v8 offset:17408
    v_cvt_pk_bf16_f32 v38, v76, v77
    v_mfma_f32_16x16x32_bf16 v[124:127], a[20:23], a[0:3], v[124:127]
    ds_read_b128 a[232:235], v9 offset:17408
    v_cvt_pk_bf16_f32 v39, v78, v79
    v_mfma_f32_16x16x32_bf16 v[128:131], a[20:23], a[4:7], v[128:131]
    v_exp_f32 v40, v40
    v_mfma_f32_16x16x32_bf16 v[132:135], a[20:23], a[8:11], v[132:135]
    v_exp_f32 v41, v41
    v_mfma_f32_16x16x32_bf16 v[136:139], a[20:23], a[12:15], v[136:139]
    s_add_u32 s60, s7, 6144
    buffer_load_dwordx4 v4, s[36:39], s60 offen offset:2048 lds
    v_mfma_f32_16x16x32_bf16 v[140:143], a[20:23], a[16:19], v[140:143]
    ds_read_b128 a[236:239], v10 offset:17408
    v_mfma_f32_16x16x32_bf16 v[144:147], a[24:27], a[0:3], v[144:147]
    v_mfma_f32_16x16x32_bf16 v[148:151], a[24:27], a[4:7], v[148:151]
    v_exp_f32 v42, v42
    v_mfma_f32_16x16x32_bf16 v[152:155], a[24:27], a[8:11], v[152:155]
    ds_write_b128 v5, v[36:39] offset:3072
    v_mfma_f32_16x16x32_bf16 v[156:159], a[24:27], a[12:15], v[156:159]
    v_exp_f32 v43, v43
    v_mfma_f32_16x16x32_bf16 v[160:163], a[24:27], a[16:19], v[160:163]
    s_waitcnt lgkmcnt(5)
    v_exp_f32 v80, v80
    v_mfma_f32_16x16x32_bf16 v[44:47], a[208:211], v[84:87], v[204:207]
    v_exp_f32 v81, v81
    v_mfma_f32_16x16x32_bf16 v[44:47], a[212:215], v[104:107], v[44:47]
    v_exp_f32 v82, v82
    v_mfma_f32_16x16x32_bf16 v[44:47], a[216:219], a[40:43], v[44:47]
    s_add_u32 s60, s7, 9216
    buffer_load_dwordx4 v255, s[36:39], s60 offen offset:3072 lds
    v_mfma_f32_16x16x32_bf16 v[44:47], a[220:223], a[60:63], v[44:47]
    s_waitcnt lgkmcnt(1)
    ds_read_b64_tr_b16 a[28:29], v17 offset:16384
    v_cvt_pk_bf16_f32 v40, v40, v41
    v_mfma_f32_16x16x32_bf16 v[64:67], a[224:227], v[84:87], v[204:207]
    ds_read_b64_tr_b16 a[30:31], v17 offset:17408
    v_cvt_pk_bf16_f32 v41, v42, v43
    v_mfma_f32_16x16x32_bf16 v[64:67], a[228:231], v[104:107], v[64:67]
    v_exp_f32 v83, v83
    v_mfma_f32_16x16x32_bf16 v[64:67], a[232:235], a[40:43], v[64:67]
    ds_read_b64_tr_b16 a[32:33], v18 offset:16384
    v_cvt_pk_bf16_f32 v42, v80, v81
    v_mfma_f32_16x16x32_bf16 v[64:67], a[236:239], a[60:63], v[64:67]
    ds_read_b64_tr_b16 a[34:35], v18 offset:17408
    v_cvt_pk_bf16_f32 v43, v82, v83
    v_mfma_f32_16x16x32_bf16 v[48:51], a[208:211], v[88:91], v[208:211]
    v_exp_f32 v44, v44
    v_mfma_f32_16x16x32_bf16 v[48:51], a[212:215], v[108:111], v[48:51]
    v_exp_f32 v45, v45
    v_mfma_f32_16x16x32_bf16 v[48:51], a[216:219], a[44:47], v[48:51]
    v_exp_f32 v46, v46
    v_mfma_f32_16x16x32_bf16 v[48:51], a[220:223], a[64:67], v[48:51]
    v_exp_f32 v47, v47
    v_mfma_f32_16x16x32_bf16 v[68:71], a[224:227], v[88:91], v[208:211]
    v_cvt_pk_bf16_f32 v44, v44, v45
    v_mfma_f32_16x16x32_bf16 v[68:71], a[228:231], v[108:111], v[68:71]
    v_cvt_pk_bf16_f32 v45, v46, v47
    v_mfma_f32_16x16x32_bf16 v[68:71], a[232:235], a[44:47], v[68:71]
    ds_write_b128 v5, v[40:43] offset:4096
    v_mfma_f32_16x16x32_bf16 v[68:71], a[236:239], a[64:67], v[68:71]
    s_waitcnt lgkmcnt(3)
    v_exp_f32 v64, v64
    v_mfma_f32_16x16x32_bf16 v[164:167], a[28:31], a[0:3], v[164:167]
    v_exp_f32 v65, v65
    v_mfma_f32_16x16x32_bf16 v[168:171], a[28:31], a[4:7], v[168:171]
    v_exp_f32 v66, v66
    v_mfma_f32_16x16x32_bf16 v[172:175], a[28:31], a[8:11], v[172:175]
    v_exp_f32 v67, v67
    v_mfma_f32_16x16x32_bf16 v[176:179], a[28:31], a[12:15], v[176:179]
    v_cvt_pk_bf16_f32 v46, v64, v65
    v_mfma_f32_16x16x32_bf16 v[180:183], a[28:31], a[16:19], v[180:183]
    s_waitcnt lgkmcnt(1)
    v_cvt_pk_bf16_f32 v47, v66, v67
    v_mfma_f32_16x16x32_bf16 v[184:187], a[32:35], a[0:3], v[184:187]
    v_exp_f32 v48, v48
    v_mfma_f32_16x16x32_bf16 v[188:191], a[32:35], a[4:7], v[188:191]
    v_exp_f32 v49, v49
    v_mfma_f32_16x16x32_bf16 v[192:195], a[32:35], a[8:11], v[192:195]
    v_exp_f32 v50, v50
    v_mfma_f32_16x16x32_bf16 v[196:199], a[32:35], a[12:15], v[196:199]
    v_exp_f32 v51, v51
    v_mfma_f32_16x16x32_bf16 v[200:203], a[32:35], a[16:19], v[200:203]
    s_waitcnt vmcnt(4) lgkmcnt(0)
    s_barrier
    v_cvt_pk_bf16_f32 v48, v48, v49
    v_mfma_f32_16x16x32_bf16 v[52:55], a[208:211], v[92:95], v[212:215]
    ds_read_b64_tr_b16 a[240:241], v11 offset:32768
    v_cvt_pk_bf16_f32 v49, v50, v51
    v_mfma_f32_16x16x32_bf16 v[52:55], a[212:215], v[112:115], v[52:55]
    s_add_u32 m0, s61, 16384
    ds_write_b128 v5, v[44:47] offset:5120
    v_mfma_f32_16x16x32_bf16 v[52:55], a[216:219], a[48:51], v[52:55]
    s_add_u32 s60, s7, 65536
    buffer_load_dwordx4 v4, s[36:39], s60 offen offset:0 lds
    v_exp_f32 v68, v68
    v_mfma_f32_16x16x32_bf16 v[52:55], a[220:223], a[68:71], v[52:55]
    ds_read_b64_tr_b16 a[242:243], v11 offset:33792
    v_exp_f32 v69, v69
    v_mfma_f32_16x16x32_bf16 v[72:75], a[224:227], v[92:95], v[212:215]
    ds_read_b64_tr_b16 a[244:245], v12 offset:32768
    v_exp_f32 v70, v70
    v_mfma_f32_16x16x32_bf16 v[72:75], a[228:231], v[112:115], v[72:75]
    ds_read_b64_tr_b16 a[246:247], v12 offset:33792
    v_exp_f32 v71, v71
    v_mfma_f32_16x16x32_bf16 v[72:75], a[232:235], a[48:51], v[72:75]
    ds_read_b64_tr_b16 a[248:249], v13 offset:32768
    v_cvt_pk_bf16_f32 v50, v68, v69
    v_mfma_f32_16x16x32_bf16 v[72:75], a[236:239], a[68:71], v[72:75]
    ds_read_b64_tr_b16 a[250:251], v13 offset:33792
    v_cvt_pk_bf16_f32 v51, v70, v71
    v_mfma_f32_16x16x32_bf16 v[56:59], a[208:211], v[96:99], v[216:219]
    s_add_u32 s60, s7, 68608
    ds_write_b128 v5, v[48:51] offset:6144
    buffer_load_dwordx4 v255, s[36:39], s60 offen offset:1024 lds
    v_mfma_f32_16x16x32_bf16 v[56:59], a[212:215], v[116:119], v[56:59]
    v_exp_f32 v52, v52
    v_mfma_f32_16x16x32_bf16 v[56:59], a[216:219], a[52:55], v[56:59]
    ds_read_b64_tr_b16 a[252:253], v14 offset:32768
    v_exp_f32 v53, v53
    v_mfma_f32_16x16x32_bf16 v[56:59], a[220:223], a[72:75], v[56:59]
    ds_read_b64_tr_b16 a[254:255], v14 offset:33792
    v_exp_f32 v54, v54
    v_mfma_f32_16x16x32_bf16 v[76:79], a[224:227], v[96:99], v[216:219]
    ds_read_b128 a[0:3], v6 offset:0
    v_exp_f32 v55, v55
    v_mfma_f32_16x16x32_bf16 v[76:79], a[228:231], v[116:119], v[76:79]
    ds_read_b128 a[4:7], v6 offset:1024
    v_cvt_pk_bf16_f32 v52, v52, v53
    v_mfma_f32_16x16x32_bf16 v[76:79], a[232:235], a[52:55], v[76:79]
    s_add_u32 s60, s7, 71680
    buffer_load_dwordx4 v4, s[36:39], s60 offen offset:2048 lds
    v_cvt_pk_bf16_f32 v53, v54, v55
    v_mfma_f32_16x16x32_bf16 v[76:79], a[236:239], a[72:75], v[76:79]
    ds_read_b128 a[8:11], v6 offset:2048
    v_exp_f32 v72, v72
    v_mfma_f32_16x16x32_bf16 v[60:63], a[208:211], v[100:103], v[220:223]
    ds_read_b128 a[12:15], v6 offset:3072
    v_exp_f32 v73, v73
    v_mfma_f32_16x16x32_bf16 v[60:63], a[212:215], v[120:123], v[60:63]
    ds_read_b128 a[16:19], v6 offset:4096
    v_exp_f32 v74, v74
    v_mfma_f32_16x16x32_bf16 v[60:63], a[216:219], a[56:59], v[60:63]
    ds_read_b64_tr_b16 a[20:21], v15 offset:32768
    v_exp_f32 v75, v75
    v_mfma_f32_16x16x32_bf16 v[60:63], a[220:223], a[76:79], v[60:63]
    ds_read_b64_tr_b16 a[22:23], v15 offset:33792
    v_cvt_pk_bf16_f32 v54, v72, v73
    v_mfma_f32_16x16x32_bf16 v[80:83], a[224:227], v[100:103], v[220:223]
    s_add_u32 s60, s7, 74752
    buffer_load_dwordx4 v255, s[36:39], s60 offen offset:3072 lds
    v_cvt_pk_bf16_f32 v55, v74, v75
    v_mfma_f32_16x16x32_bf16 v[80:83], a[228:231], v[120:123], v[80:83]
    ds_write_b128 v5, v[52:55] offset:7168
    v_mfma_f32_16x16x32_bf16 v[80:83], a[232:235], a[56:59], v[80:83]
    v_exp_f32 v56, v56
    v_mfma_f32_16x16x32_bf16 v[80:83], a[236:239], a[76:79], v[80:83]
    ds_read_b64_tr_b16 a[24:25], v16 offset:32768
    v_exp_f32 v57, v57
    v_mfma_f32_16x16x32_bf16 v[224:227], a[36:39], v[24:27], v[224:227]
    ds_read_b64_tr_b16 a[26:27], v16 offset:33792
    v_exp_f32 v58, v58
    v_mfma_f32_16x16x32_bf16 v[228:231], a[36:39], v[28:31], v[228:231]
    s_add_u32 m0, s61, 65536
    ds_read_b64_tr_b16 a[28:29], v17 offset:32768
    v_exp_f32 v59, v59
    v_mfma_f32_16x16x32_bf16 v[232:235], a[36:39], v[32:35], v[232:235]
    s_add_u32 s60, s8, 0
    buffer_load_dwordx4 v4, s[36:39], s60 offen offset:0 lds
    v_cvt_pk_bf16_f32 v56, v56, v57
    v_mfma_f32_16x16x32_bf16 v[236:239], a[36:39], v[36:39], v[236:239]
    ds_read_b64_tr_b16 a[30:31], v17 offset:33792
    v_cvt_pk_bf16_f32 v57, v58, v59
    v_mfma_f32_16x16x32_bf16 v[240:243], a[36:39], v[40:43], v[240:243]
    s_waitcnt lgkmcnt(14)
    ds_read_b64_tr_b16 a[32:33], v18 offset:32768
    v_exp_f32 v76, v76
    v_mfma_f32_16x16x32_bf16 v[124:127], a[240:243], v[24:27], v[124:127]
    ds_read_b64_tr_b16 a[34:35], v18 offset:33792
    v_exp_f32 v77, v77
    v_mfma_f32_16x16x32_bf16 v[128:131], a[240:243], v[28:31], v[128:131]
    ds_read_b64_tr_b16 a[80:81], v246 offset:32768
    v_exp_f32 v78, v78
    v_mfma_f32_16x16x32_bf16 v[132:135], a[240:243], v[32:35], v[132:135]
    ds_read_b64_tr_b16 a[82:83], v246 offset:36864
    v_exp_f32 v79, v79
    v_mfma_f32_16x16x32_bf16 v[136:139], a[240:243], v[36:39], v[136:139]
    s_add_u32 s60, s8, 3072
    buffer_load_dwordx4 v255, s[36:39], s60 offen offset:1024 lds
    v_cvt_pk_bf16_f32 v58, v76, v77
    v_mfma_f32_16x16x32_bf16 v[140:143], a[240:243], v[40:43], v[140:143]
    ds_read_b64_tr_b16 a[84:85], v247 offset:32768
    v_cvt_pk_bf16_f32 v59, v78, v79
    v_mfma_f32_16x16x32_bf16 v[144:147], a[244:247], v[24:27], v[144:147]
    ds_write_b128 v5, v[56:59] offset:8192
    v_mfma_f32_16x16x32_bf16 v[148:151], a[244:247], v[28:31], v[148:151]
    v_exp_f32 v60, v60
    v_mfma_f32_16x16x32_bf16 v[152:155], a[244:247], v[32:35], v[152:155]
    ds_read_b64_tr_b16 a[86:87], v247 offset:36864
    v_exp_f32 v61, v61
    v_mfma_f32_16x16x32_bf16 v[156:159], a[244:247], v[36:39], v[156:159]
    ds_read_b64_tr_b16 a[88:89], v246 offset:40960
    v_exp_f32 v62, v62
    v_mfma_f32_16x16x32_bf16 v[160:163], a[244:247], v[40:43], v[160:163]
    s_waitcnt lgkmcnt(14)
    s_add_u32 s60, s8, 6144
    buffer_load_dwordx4 v4, s[36:39], s60 offen offset:2048 lds
    v_exp_f32 v63, v63
    v_mfma_f32_16x16x32_bf16 v[164:167], a[248:251], v[24:27], v[164:167]
    ds_read_b64_tr_b16 a[90:91], v246 offset:45056
    v_cvt_pk_bf16_f32 v60, v60, v61
    v_mfma_f32_16x16x32_bf16 v[168:171], a[248:251], v[28:31], v[168:171]
    ds_read_b64_tr_b16 a[92:93], v247 offset:40960
    v_cvt_pk_bf16_f32 v61, v62, v63
    v_mfma_f32_16x16x32_bf16 v[172:175], a[248:251], v[32:35], v[172:175]
    ds_read_b64_tr_b16 a[94:95], v247 offset:45056
    v_exp_f32 v80, v80
    v_mfma_f32_16x16x32_bf16 v[176:179], a[248:251], v[36:39], v[176:179]
    ds_read_b64_tr_b16 a[96:97], v246 offset:0
    v_exp_f32 v81, v81
    v_mfma_f32_16x16x32_bf16 v[180:183], a[248:251], v[40:43], v[180:183]
    ds_read_b64_tr_b16 a[98:99], v246 offset:4096
    v_exp_f32 v82, v82
    v_mfma_f32_16x16x32_bf16 v[184:187], a[252:255], v[24:27], v[184:187]
    s_add_u32 s60, s8, 9216
    buffer_load_dwordx4 v255, s[36:39], s60 offen offset:3072 lds
    v_exp_f32 v83, v83
    v_mfma_f32_16x16x32_bf16 v[188:191], a[252:255], v[28:31], v[188:191]
    ds_read_b64_tr_b16 a[100:101], v247 offset:0
    v_cvt_pk_bf16_f32 v62, v80, v81
    v_mfma_f32_16x16x32_bf16 v[192:195], a[252:255], v[32:35], v[192:195]
    ds_read_b64_tr_b16 a[102:103], v247 offset:4096
    v_cvt_pk_bf16_f32 v63, v82, v83
    v_mfma_f32_16x16x32_bf16 v[196:199], a[252:255], v[36:39], v[196:199]
    ds_write_b128 v5, v[60:63] offset:9216
    v_mfma_f32_16x16x32_bf16 v[200:203], a[252:255], v[40:43], v[200:203]
    s_waitcnt lgkmcnt(14)
    v_mfma_f32_16x16x32_bf16 v[124:127], a[20:23], a[0:3], v[124:127]
    ds_read_b64_tr_b16 a[104:105], v246 offset:8192
    v_mfma_f32_16x16x32_bf16 v[128:131], a[20:23], a[4:7], v[128:131]
    ds_read_b64_tr_b16 a[106:107], v246 offset:12288
    v_mfma_f32_16x16x32_bf16 v[132:135], a[20:23], a[8:11], v[132:135]
    ds_read_b64_tr_b16 a[108:109], v247 offset:8192
    v_mfma_f32_16x16x32_bf16 v[136:139], a[20:23], a[12:15], v[136:139]
    ds_read_b64_tr_b16 a[110:111], v247 offset:12288
    v_mfma_f32_16x16x32_bf16 v[140:143], a[20:23], a[16:19], v[140:143]
    v_mfma_f32_16x16x32_bf16 v[144:147], a[24:27], a[0:3], v[144:147]
    v_mfma_f32_16x16x32_bf16 v[148:151], a[24:27], a[4:7], v[148:151]
    v_mfma_f32_16x16x32_bf16 v[152:155], a[24:27], a[8:11], v[152:155]
    v_mfma_f32_16x16x32_bf16 v[156:159], a[24:27], a[12:15], v[156:159]
    v_mfma_f32_16x16x32_bf16 v[160:163], a[24:27], a[16:19], v[160:163]
    v_mfma_f32_16x16x32_bf16 v[224:227], a[36:39], v[44:47], v[224:227]
    s_mul_i32 s58, s3, 1280
    v_mfma_f32_16x16x32_bf16 v[228:231], a[36:39], v[48:51], v[228:231]
    s_add_u32 s58, s58, 155648
    v_lshl_add_u32 v244, v1, 2, s58
    v_add_u32 v247, 160768, v21
    v_mfma_f32_16x16x32_bf16 v[232:235], a[36:39], v[52:55], v[232:235]
    s_lshl_b32 s59, s3, 2
    v_add_u32 v246, s59, v247
    v_mfma_f32_16x16x32_bf16 v[236:239], a[36:39], v[56:59], v[236:239]
    s_xor_b32 s59, s3, 1
    v_mfma_f32_16x16x32_bf16 v[240:243], a[36:39], v[60:63], v[240:243]
    s_mul_i32 s59, s59, 1280
    v_mfma_f32_16x16x32_bf16 v[164:167], a[28:31], a[0:3], v[164:167]
    s_add_u32 s59, s59, 155648
    ds_write_b32 v244, v224 offset:0
    v_lshl_add_u32 v245, v1, 2, s59
    v_mfma_f32_16x16x32_bf16 v[168:171], a[28:31], a[4:7], v[168:171]
    s_mul_i32 s58, s2, 40960
    ds_write_b32 v244, v228 offset:256
    v_mfma_f32_16x16x32_bf16 v[172:175], a[28:31], a[8:11], v[172:175]
    s_mul_i32 s59, s3, 2048
    ds_write_b32 v244, v232 offset:512
    v_mfma_f32_16x16x32_bf16 v[176:179], a[28:31], a[12:15], v[176:179]
    s_add_u32 s57, s58, s59
    ds_write_b32 v244, v236 offset:768
    v_max3_f32 v248, v224, v228, v232
    v_mfma_f32_16x16x32_bf16 v[180:183], a[28:31], a[16:19], v[180:183]
    ds_write_b32 v244, v240 offset:1024
    v_max3_f32 v248, v248, v236, v240
    v_mfma_f32_16x16x32_bf16 v[184:187], a[32:35], a[0:3], v[184:187]
    ds_write_b32 v246, v248
    v_mfma_f32_16x16x32_bf16 v[188:191], a[32:35], a[4:7], v[188:191]
    v_mfma_f32_16x16x32_bf16 v[192:195], a[32:35], a[8:11], v[192:195]
    v_mfma_f32_16x16x32_bf16 v[196:199], a[32:35], a[12:15], v[196:199]
    v_mfma_f32_16x16x32_bf16 v[200:203], a[32:35], a[16:19], v[200:203]
    s_waitcnt lgkmcnt(0)
    s_barrier
    ds_read_b64_tr_b16 a[240:241], v11 offset:49152
    ds_read_b64_tr_b16 a[242:243], v11 offset:50176
    ds_read_b64_tr_b16 a[244:245], v12 offset:49152
    ds_read_b64_tr_b16 a[246:247], v12 offset:50176
    ds_read_b128 v[248:251], v247
    ds_read_b64_tr_b16 a[248:249], v13 offset:49152
    ds_read_b64_tr_b16 a[250:251], v13 offset:50176
    ds_read_b64_tr_b16 a[252:253], v14 offset:49152
    ds_read_b64_tr_b16 a[254:255], v14 offset:50176
    ds_read_b128 a[0:3], v6 offset:5120
    s_waitcnt lgkmcnt(6)
    v_mfma_f32_16x16x32_bf16 v[124:127], a[240:243], v[44:47], v[124:127]
    ds_read_b64_tr_b16 a[20:21], v15 offset:49152
    ds_read_b64_tr_b16 a[22:23], v15 offset:50176
    v_mfma_f32_16x16x32_bf16 v[144:147], a[244:247], v[44:47], v[144:147]
    s_waitcnt lgkmcnt(3)
    s_add_u32 m0, s61, 81920
    ds_read_b64_tr_b16 a[24:25], v16 offset:49152
    ds_read_b64_tr_b16 a[26:27], v16 offset:50176
    v_mfma_f32_16x16x32_bf16 v[164:167], a[248:251], v[44:47], v[164:167]
    s_add_u32 s60, s8, 65536
    ds_read_b64_tr_b16 a[28:29], v17 offset:49152
    ds_read_b64_tr_b16 a[30:31], v17 offset:50176
    buffer_load_dwordx4 v4, s[36:39], s60 offen offset:0 lds
    v_mfma_f32_16x16x32_bf16 v[184:187], a[252:255], v[44:47], v[184:187]
    s_waitcnt lgkmcnt(4)
    ds_read_b64_tr_b16 a[32:33], v18 offset:49152
    ds_read_b64_tr_b16 a[34:35], v18 offset:50176
    v_mfma_f32_16x16x32_bf16 v[124:127], a[20:23], a[0:3], v[124:127]
    s_waitcnt lgkmcnt(4)
    ds_read_b32 v225, v245 offset:0
    ds_read_b32 v229, v245 offset:256
    v_mfma_f32_16x16x32_bf16 v[144:147], a[24:27], a[0:3], v[144:147]
    s_waitcnt lgkmcnt(4)
    ds_read_b32 v233, v245 offset:512
    ds_read_b32 v237, v245 offset:768
    v_mfma_f32_16x16x32_bf16 v[164:167], a[28:31], a[0:3], v[164:167]
    s_waitcnt lgkmcnt(4)
    s_add_u32 s60, s8, 68608
    ds_read_b32 v241, v245 offset:1024
    ds_read_b128 a[4:7], v6 offset:6144
    buffer_load_dwordx4 v255, s[36:39], s60 offen offset:1024 lds
    v_mfma_f32_16x16x32_bf16 v[184:187], a[32:35], a[0:3], v[184:187]
    ds_read_b128 a[8:11], v6 offset:7168
    ds_read_b128 a[12:15], v6 offset:8192
    v_mfma_f32_16x16x32_bf16 v[128:131], a[240:243], v[48:51], v[128:131]
    s_waitcnt lgkmcnt(3)
    ds_read_b128 a[16:19], v6 offset:9216
    v_mfma_f32_16x16x32_bf16 v[148:151], a[244:247], v[48:51], v[148:151]
    v_max3_f32 v248, v248, v249, v250
    v_max_f32 v248, v248, v251
    v_mfma_f32_16x16x32_bf16 v[168:171], a[248:251], v[48:51], v[168:171]
    s_add_u32 s60, s8, 71680
    buffer_load_dwordx4 v4, s[36:39], s60 offen offset:2048 lds
    v_cmp_lt_f32 vcc, 0x4e800000, v248
    v_add_f32 v224, v224, v225
    v_mfma_f32_16x16x32_bf16 v[188:191], a[252:255], v[48:51], v[188:191]
    s_waitcnt lgkmcnt(3)
    v_add_f32 v228, v228, v229
    v_add_f32 v232, v232, v233
    v_mfma_f32_16x16x32_bf16 v[128:131], a[20:23], a[4:7], v[128:131]
    v_add_f32 v236, v236, v237
    v_add_f32 v240, v240, v241
    v_mfma_f32_16x16x32_bf16 v[148:151], a[24:27], a[4:7], v[148:151]
    v_rcp_f32 v224, v224
    v_mfma_f32_16x16x32_bf16 v[168:171], a[28:31], a[4:7], v[168:171]
    s_add_u32 s60, s8, 74752
    buffer_load_dwordx4 v255, s[36:39], s60 offen offset:3072 lds
    v_rcp_f32 v228, v228
    v_mfma_f32_16x16x32_bf16 v[188:191], a[32:35], a[4:7], v[188:191]
    v_rcp_f32 v232, v232
    v_rcp_f32 v236, v236
    v_rcp_f32 v240, v240
    s_cbranch_vccnz L_fallback
L_nofb:
    v_mfma_f32_16x16x32_bf16 v[132:135], a[240:243], v[52:55], v[132:135]
    s_add_u32 s59, s57, 0
    v_mul_f32 v124, v124, v224
    v_mul_f32 v125, v125, v224
    v_mfma_f32_16x16x32_bf16 v[152:155], a[244:247], v[52:55], v[152:155]
    s_add_u32 m0, s61, 32768
    v_mul_f32 v126, v126, v224
    v_mul_f32 v127, v127, v224
    v_mfma_f32_16x16x32_bf16 v[172:175], a[248:251], v[52:55], v[172:175]
    s_add_u32 s60, s9, 0
    buffer_load_dwordx4 v4, s[36:39], s60 offen offset:0 lds
    v_cvt_pk_bf16_f32 v24, v124, v125
    v_mfma_f32_16x16x32_bf16 v[192:195], a[252:255], v[52:55], v[192:195]
    s_waitcnt lgkmcnt(0)
    v_cvt_pk_bf16_f32 v25, v126, v127
    v_mul_f32 v144, v144, v224
    v_mfma_f32_16x16x32_bf16 v[132:135], a[20:23], a[8:11], v[132:135]
    v_mul_f32 v145, v145, v224
    v_mul_f32 v146, v146, v224
    v_mfma_f32_16x16x32_bf16 v[152:155], a[24:27], a[8:11], v[152:155]
    s_add_u32 s60, s9, 3072
    buffer_load_dwordx4 v255, s[36:39], s60 offen offset:1024 lds
    v_mul_f32 v147, v147, v224
    v_mfma_f32_16x16x32_bf16 v[172:175], a[28:31], a[8:11], v[172:175]
    v_cvt_pk_bf16_f32 v26, v144, v145
    v_cvt_pk_bf16_f32 v27, v146, v147
    v_mfma_f32_16x16x32_bf16 v[192:195], a[32:35], a[8:11], v[192:195]
    buffer_store_dwordx4 v[24:27], v21, s[48:51], s59 offen sc1
    v_mfma_f32_16x16x32_bf16 v[136:139], a[240:243], v[56:59], v[136:139]
    s_add_u32 s60, s9, 6144
    buffer_load_dwordx4 v4, s[36:39], s60 offen offset:2048 lds
    v_mul_f32 v164, v164, v224
    v_mfma_f32_16x16x32_bf16 v[156:159], a[244:247], v[56:59], v[156:159]
    v_mul_f32 v165, v165, v224
    v_mul_f32 v166, v166, v224
    v_mfma_f32_16x16x32_bf16 v[176:179], a[248:251], v[56:59], v[176:179]
    v_mul_f32 v167, v167, v224
    v_cvt_pk_bf16_f32 v64, v164, v165
    v_mfma_f32_16x16x32_bf16 v[196:199], a[252:255], v[56:59], v[196:199]
    s_add_u32 s60, s9, 9216
    buffer_load_dwordx4 v255, s[36:39], s60 offen offset:3072 lds
    v_cvt_pk_bf16_f32 v65, v166, v167
    v_mfma_f32_16x16x32_bf16 v[136:139], a[20:23], a[12:15], v[136:139]
    v_mul_f32 v184, v184, v224
    v_mul_f32 v185, v185, v224
    v_mfma_f32_16x16x32_bf16 v[156:159], a[24:27], a[12:15], v[156:159]
    v_mul_f32 v186, v186, v224
    v_mul_f32 v187, v187, v224
    v_mfma_f32_16x16x32_bf16 v[176:179], a[28:31], a[12:15], v[176:179]
    v_cvt_pk_bf16_f32 v66, v184, v185
    v_cvt_pk_bf16_f32 v67, v186, v187
    v_mfma_f32_16x16x32_bf16 v[196:199], a[32:35], a[12:15], v[196:199]
    buffer_store_dwordx4 v[64:67], v21, s[48:51], s59 offen offset:1024 sc1
    v_mfma_f32_16x16x32_bf16 v[140:143], a[240:243], v[60:63], v[140:143]
    s_add_u32 s59, s57, 8192
    v_mul_f32 v128, v128, v228
    v_mul_f32 v129, v129, v228
    v_mfma_f32_16x16x32_bf16 v[160:163], a[244:247], v[60:63], v[160:163]
    v_mul_f32 v130, v130, v228
    v_mul_f32 v131, v131, v228
    v_mfma_f32_16x16x32_bf16 v[180:183], a[248:251], v[60:63], v[180:183]
    v_cvt_pk_bf16_f32 v28, v128, v129
    v_cvt_pk_bf16_f32 v29, v130, v131
    v_mfma_f32_16x16x32_bf16 v[200:203], a[252:255], v[60:63], v[200:203]
    v_mul_f32 v148, v148, v228
    v_mul_f32 v149, v149, v228
    v_mfma_f32_16x16x32_bf16 v[140:143], a[20:23], a[16:19], v[140:143]
    v_mul_f32 v150, v150, v228
    v_mul_f32 v151, v151, v228
    v_mfma_f32_16x16x32_bf16 v[160:163], a[24:27], a[16:19], v[160:163]
    v_cvt_pk_bf16_f32 v30, v148, v149
    v_cvt_pk_bf16_f32 v31, v150, v151
    v_mfma_f32_16x16x32_bf16 v[180:183], a[28:31], a[16:19], v[180:183]
    buffer_store_dwordx4 v[28:31], v21, s[48:51], s59 offen sc1
    v_mfma_f32_16x16x32_bf16 v[200:203], a[32:35], a[16:19], v[200:203]
    v_mul_f32 v168, v168, v228
    v_mul_f32 v169, v169, v228
    v_mul_f32 v170, v170, v228
    v_mul_f32 v171, v171, v228
    v_cvt_pk_bf16_f32 v68, v168, v169
    v_cvt_pk_bf16_f32 v69, v170, v171
    v_mul_f32 v188, v188, v228
    v_mul_f32 v189, v189, v228
    v_mul_f32 v190, v190, v228
    v_mul_f32 v191, v191, v228
    v_cvt_pk_bf16_f32 v70, v188, v189
    v_cvt_pk_bf16_f32 v71, v190, v191
    buffer_store_dwordx4 v[68:71], v21, s[48:51], s59 offen offset:1024 sc1
    v_pk_mul_f32 v[132:133], v[132:133], v[232:233] op_sel_hi:[1,0]
    v_pk_mul_f32 v[134:135], v[134:135], v[232:233] op_sel_hi:[1,0]
    v_cvt_pk_bf16_f32 v32, v132, v133
    v_cvt_pk_bf16_f32 v33, v134, v135
    ds_write_b128 v6, v[24:27] offset:0
    v_pk_mul_f32 v[152:153], v[152:153], v[232:233] op_sel_hi:[1,0]
    v_pk_mul_f32 v[154:155], v[154:155], v[232:233] op_sel_hi:[1,0]
    v_cvt_pk_bf16_f32 v34, v152, v153
    v_cvt_pk_bf16_f32 v35, v154, v155
    s_add_u32 s59, s57, 16384
    buffer_store_dwordx4 v[32:35], v21, s[48:51], s59 offen sc1
    ds_write_b128 v6, v[32:35] offset:2048
    v_pk_mul_f32 v[172:173], v[172:173], v[232:233] op_sel_hi:[1,0]
    v_pk_mul_f32 v[174:175], v[174:175], v[232:233] op_sel_hi:[1,0]
    v_cvt_pk_bf16_f32 v72, v172, v173
    v_cvt_pk_bf16_f32 v73, v174, v175
    ds_write_b128 v6, v[64:67] offset:5120
    v_pk_mul_f32 v[192:193], v[192:193], v[232:233] op_sel_hi:[1,0]
    v_pk_mul_f32 v[194:195], v[194:195], v[232:233] op_sel_hi:[1,0]
    v_cvt_pk_bf16_f32 v74, v192, v193
    v_cvt_pk_bf16_f32 v75, v194, v195
    buffer_store_dwordx4 v[72:75], v21, s[48:51], s59 offen offset:1024 sc1
    ds_write_b128 v6, v[72:75] offset:7168
    v_pk_mul_f32 v[136:137], v[136:137], v[236:237] op_sel_hi:[1,0]
    v_pk_mul_f32 v[138:139], v[138:139], v[236:237] op_sel_hi:[1,0]
    v_cvt_pk_bf16_f32 v36, v136, v137
    v_cvt_pk_bf16_f32 v37, v138, v139
    ds_write_b128 v6, v[28:31] offset:1024
    v_pk_mul_f32 v[156:157], v[156:157], v[236:237] op_sel_hi:[1,0]
    v_pk_mul_f32 v[158:159], v[158:159], v[236:237] op_sel_hi:[1,0]
    v_cvt_pk_bf16_f32 v38, v156, v157
    v_cvt_pk_bf16_f32 v39, v158, v159
    ds_write_b128 v6, v[36:39] offset:3072
    v_pk_mul_f32 v[176:177], v[176:177], v[236:237] op_sel_hi:[1,0]
    v_pk_mul_f32 v[178:179], v[178:179], v[236:237] op_sel_hi:[1,0]
    v_cvt_pk_bf16_f32 v76, v176, v177
    v_cvt_pk_bf16_f32 v77, v178, v179
    ds_write_b128 v6, v[68:71] offset:6144
    v_pk_mul_f32 v[196:197], v[196:197], v[236:237] op_sel_hi:[1,0]
    v_pk_mul_f32 v[198:199], v[198:199], v[236:237] op_sel_hi:[1,0]
    v_cvt_pk_bf16_f32 v78, v196, v197
    v_cvt_pk_bf16_f32 v79, v198, v199
    ds_write_b128 v6, v[76:79] offset:8192
    v_pk_mul_f32 v[140:141], v[140:141], v[240:241] op_sel_hi:[1,0]
    v_pk_mul_f32 v[142:143], v[142:143], v[240:241] op_sel_hi:[1,0]
    v_cvt_pk_bf16_f32 v40, v140, v141
    v_cvt_pk_bf16_f32 v41, v142, v143
    v_pk_mul_f32 v[160:161], v[160:161], v[240:241] op_sel_hi:[1,0]
    v_pk_mul_f32 v[162:163], v[162:163], v[240:241] op_sel_hi:[1,0]
    v_cvt_pk_bf16_f32 v42, v160, v161
    v_cvt_pk_bf16_f32 v43, v162, v163
    ds_write_b128 v6, v[40:43] offset:4096
    v_pk_mul_f32 v[180:181], v[180:181], v[240:241] op_sel_hi:[1,0]
    v_pk_mul_f32 v[182:183], v[182:183], v[240:241] op_sel_hi:[1,0]
    v_cvt_pk_bf16_f32 v80, v180, v181
    v_cvt_pk_bf16_f32 v81, v182, v183
    v_pk_mul_f32 v[200:201], v[200:201], v[240:241] op_sel_hi:[1,0]
    v_pk_mul_f32 v[202:203], v[202:203], v[240:241] op_sel_hi:[1,0]
    v_cvt_pk_bf16_f32 v82, v200, v201
    v_cvt_pk_bf16_f32 v83, v202, v203
    ds_write_b128 v6, v[80:83] offset:9216
    v_add_u32 v7, 0x10000, v21
    v_add_u32 v8, 0x20000, v21
    v_subrev_u32 v15, 49152, v19
    v_subrev_u32 v16, 49152, v20
    s_waitcnt vmcnt(5) lgkmcnt(0)
    s_barrier
    ds_read_b128 a[0:3], v7 offset:49152
    ds_read_b128 a[4:7], v8 offset:4096
    ds_read_b128 a[8:11], v7 offset:54272
    ds_read_b128 a[12:15], v8 offset:9216
    s_waitcnt lgkmcnt(0)
    v_mfma_f32_16x16x32_bf16 v[124:127], a[80:83], a[0:3], 0
    s_add_u32 m0, s61, 0
    ds_read_b128 a[16:19], v7 offset:59392
    ds_read_b128 a[20:23], v8 offset:14336
    v_mfma_f32_16x16x32_bf16 v[164:167], a[84:87], a[0:3], 0
    s_add_u32 s60, s9, 65536
    buffer_load_dwordx4 v4, s[36:39], s60 offen offset:0 lds
    ds_read_b64_tr_b16 a[112:113], v19 offset:0
    v_mfma_f32_16x16x32_bf16 v[144:147], a[80:83], a[4:7], 0
    s_add_u32 s60, s9, 68608
    ds_read_b128 a[24:27], v7 offset:64512
    v_mfma_f32_16x16x32_bf16 v[184:187], a[84:87], a[4:7], 0
    ds_read_b64_tr_b16 a[114:115], v19 offset:4096
    ds_read_b64_tr_b16 a[116:117], v20 offset:0
    v_mfma_f32_16x16x32_bf16 v[124:127], a[88:91], a[8:11], v[124:127]
    ds_read_b128 a[28:31], v8 offset:19456
    v_mfma_f32_16x16x32_bf16 v[164:167], a[92:95], a[8:11], v[164:167]
    buffer_load_dwordx4 v255, s[36:39], s60 offen offset:1024 lds
    ds_read_b64_tr_b16 a[118:119], v20 offset:4096
    v_mfma_f32_16x16x32_bf16 v[144:147], a[88:91], a[12:15], v[144:147]
    s_add_u32 s60, s9, 71680
    ds_read_b128 a[32:35], v7 offset:50176
    v_mfma_f32_16x16x32_bf16 v[184:187], a[92:95], a[12:15], v[184:187]
    s_waitcnt lgkmcnt(7)
    ds_read_b64_tr_b16 a[120:121], v19 offset:8192
    ds_read_b64_tr_b16 a[122:123], v19 offset:12288
    v_mfma_f32_16x16x32_bf16 v[124:127], a[96:99], a[16:19], v[124:127]
    ds_read_b128 a[36:39], v8 offset:5120
    v_mfma_f32_16x16x32_bf16 v[164:167], a[100:103], a[16:19], v[164:167]
    buffer_load_dwordx4 v4, s[36:39], s60 offen offset:2048 lds
    ds_read_b64_tr_b16 a[124:125], v20 offset:8192
    v_mfma_f32_16x16x32_bf16 v[144:147], a[96:99], a[20:23], v[144:147]
    s_add_u32 s60, s9, 74752
    ds_read_b128 a[40:43], v7 offset:55296
    v_mfma_f32_16x16x32_bf16 v[184:187], a[100:103], a[20:23], v[184:187]
    s_waitcnt lgkmcnt(7)
    ds_read_b64_tr_b16 a[126:127], v20 offset:12288
    ds_read_b64_tr_b16 a[128:129], v15 offset:16384
    v_mfma_f32_16x16x32_bf16 v[124:127], a[104:107], a[24:27], v[124:127]
    ds_read_b128 a[44:47], v8 offset:10240
    s_waitcnt vmcnt(3)
    s_barrier
    buffer_store_dwordx2 v[22:23], v0, s[48:51], s33 offen offset:0 sc1
    v_mfma_f32_16x16x32_bf16 v[164:167], a[108:111], a[24:27], v[164:167]
    buffer_load_dwordx4 v255, s[36:39], s60 offen offset:3072 lds
    ds_read_b64_tr_b16 a[130:131], v15 offset:20480
    v_mfma_f32_16x16x32_bf16 v[144:147], a[104:107], a[28:31], v[144:147]
    s_lshl_b32 s62, s3, 11
    ds_read_b128 a[48:51], v7 offset:60416
    v_mfma_f32_16x16x32_bf16 v[184:187], a[108:111], a[28:31], v[184:187]
    s_waitcnt lgkmcnt(7)
    s_xor_b32 s30, s2, 8
    ds_read_b64_tr_b16 a[132:133], v16 offset:16384
    ds_read_b64_tr_b16 a[134:135], v16 offset:20480
    v_mfma_f32_16x16x32_bf16 v[128:131], a[80:83], a[32:35], 0
    s_mul_i32 s30, s30, 40960
    ds_read_b128 a[52:55], v8 offset:15360
    v_mfma_f32_16x16x32_bf16 v[168:171], a[84:87], a[32:35], 0
    s_add_u32 s30, s30, s62
    ds_read_b64_tr_b16 a[136:137], v15 offset:24576
    ds_read_b64_tr_b16 a[138:139], v15 offset:28672
    v_mfma_f32_16x16x32_bf16 v[148:151], a[80:83], a[36:39], 0
    s_xor_b32 s31, s2, 16
    ds_read_b128 a[56:59], v8 offset:0
    v_mfma_f32_16x16x32_bf16 v[188:191], a[84:87], a[36:39], 0
    s_waitcnt lgkmcnt(8)
    s_mul_i32 s31, s31, 40960
    ds_read_b64_tr_b16 a[140:141], v16 offset:24576
    ds_read_b64_tr_b16 a[142:143], v16 offset:28672
    v_mfma_f32_16x16x32_bf16 v[128:131], a[88:91], a[40:43], v[128:131]
    s_add_u32 s31, s31, s62
    ds_read_b128 a[60:63], v8 offset:20480
    v_mfma_f32_16x16x32_bf16 v[168:171], a[92:95], a[40:43], v[168:171]
    s_xor_b32 s32, s2, 24
    ds_read_b64_tr_b16 a[144:145], v19 offset:16384
    ds_read_b64_tr_b16 a[146:147], v19 offset:20480
    v_mfma_f32_16x16x32_bf16 v[148:151], a[88:91], a[44:47], v[148:151]
    s_mul_i32 s32, s32, 40960
    ds_read_b128 a[64:67], v7 offset:51200
    v_mfma_f32_16x16x32_bf16 v[188:191], a[92:95], a[44:47], v[188:191]
    s_waitcnt lgkmcnt(9)
    s_add_u32 s32, s32, s62
    ds_read_b64_tr_b16 a[148:149], v20 offset:16384
    ds_read_b64_tr_b16 a[150:151], v20 offset:20480
    v_mfma_f32_16x16x32_bf16 v[128:131], a[96:99], a[48:51], v[128:131]
    s_add_u32 s37, s57, 24576
    ds_read_b128 a[68:71], v8 offset:6144
    v_mfma_f32_16x16x32_bf16 v[168:171], a[100:103], a[48:51], v[168:171]
    s_mul_i32 s67, s2, 40960
    buffer_store_dwordx4 v[36:39], v21, s[48:51], s37 offen sc1
    v_mfma_f32_16x16x32_bf16 v[148:151], a[96:99], a[52:55], v[148:151]
    s_add_u32 s67, s67, s62
    ds_read_b128 a[72:75], v7 offset:56320
    v_mfma_f32_16x16x32_bf16 v[188:191], a[100:103], a[52:55], v[188:191]
    s_waitcnt lgkmcnt(7)
    ds_read_b64_tr_b16 a[152:153], v19 offset:24576
    ds_read_b64_tr_b16 a[154:155], v19 offset:28672
    v_mfma_f32_16x16x32_bf16 v[128:131], a[104:107], a[56:59], v[128:131]
    ds_read_b128 a[76:79], v8 offset:11264
    v_mfma_f32_16x16x32_bf16 v[168:171], a[108:111], a[56:59], v[168:171]
    ds_read_b64_tr_b16 a[156:157], v20 offset:24576
    ds_read_b64_tr_b16 a[158:159], v20 offset:28672
    v_mfma_f32_16x16x32_bf16 v[148:151], a[104:107], a[60:63], v[148:151]
    ds_read_b128 a[208:211], v7 offset:61440
    v_mfma_f32_16x16x32_bf16 v[188:191], a[108:111], a[60:63], v[188:191]
    s_waitcnt lgkmcnt(7)
    ds_read_b64_tr_b16 a[160:161], v19 offset:32768
    ds_read_b64_tr_b16 a[162:163], v19 offset:36864
    v_mfma_f32_16x16x32_bf16 v[132:135], a[80:83], a[64:67], 0
    ds_read_b128 a[212:215], v8 offset:16384
    v_mfma_f32_16x16x32_bf16 v[172:175], a[84:87], a[64:67], 0
    buffer_store_dwordx4 v[76:79], v21, s[48:51], s37 offen offset:1024 sc1
    v_mfma_f32_16x16x32_bf16 v[152:155], a[80:83], a[68:71], 0
    ds_read_b128 a[216:219], v8 offset:1024
    v_mfma_f32_16x16x32_bf16 v[192:195], a[84:87], a[68:71], 0
    s_waitcnt lgkmcnt(7)
    ds_read_b64_tr_b16 a[164:165], v20 offset:32768
    ds_read_b64_tr_b16 a[166:167], v20 offset:36864
    v_mfma_f32_16x16x32_bf16 v[132:135], a[88:91], a[72:75], v[132:135]
    ds_read_b128 a[220:223], v8 offset:21504
    v_mfma_f32_16x16x32_bf16 v[172:175], a[92:95], a[72:75], v[172:175]
    ds_read_b64_tr_b16 a[168:169], v19 offset:40960
    ds_read_b64_tr_b16 a[170:171], v19 offset:45056
    v_mfma_f32_16x16x32_bf16 v[152:155], a[88:91], a[76:79], v[152:155]
    ds_read_b128 a[0:3], v7 offset:52224
    v_mfma_f32_16x16x32_bf16 v[192:195], a[92:95], a[76:79], v[192:195]
    s_waitcnt lgkmcnt(7)
    ds_read_b64_tr_b16 a[172:173], v20 offset:40960
    ds_read_b64_tr_b16 a[174:175], v20 offset:45056
    v_mfma_f32_16x16x32_bf16 v[132:135], a[96:99], a[208:211], v[132:135]
    s_add_u32 s38, s57, 32768
    ds_read_b128 a[4:7], v8 offset:7168
    v_mfma_f32_16x16x32_bf16 v[172:175], a[100:103], a[208:211], v[172:175]
    buffer_store_dwordx4 v[40:43], v21, s[48:51], s38 offen sc1
    v_mfma_f32_16x16x32_bf16 v[152:155], a[96:99], a[212:215], v[152:155]
    ds_read_b128 a[8:11], v7 offset:57344
    v_mfma_f32_16x16x32_bf16 v[192:195], a[100:103], a[212:215], v[192:195]
    s_waitcnt lgkmcnt(7)
    ds_read_b64_tr_b16 a[176:177], v15 offset:32768
    ds_read_b64_tr_b16 a[178:179], v15 offset:36864
    v_mfma_f32_16x16x32_bf16 v[132:135], a[104:107], a[216:219], v[132:135]
    ds_read_b128 a[12:15], v8 offset:12288
    v_mfma_f32_16x16x32_bf16 v[172:175], a[108:111], a[216:219], v[172:175]
    ds_read_b64_tr_b16 a[180:181], v16 offset:32768
    ds_read_b64_tr_b16 a[182:183], v16 offset:36864
    v_mfma_f32_16x16x32_bf16 v[152:155], a[104:107], a[220:223], v[152:155]
    ds_read_b128 a[16:19], v7 offset:62464
    v_mfma_f32_16x16x32_bf16 v[192:195], a[108:111], a[220:223], v[192:195]
    s_waitcnt lgkmcnt(7)
    ds_read_b64_tr_b16 a[184:185], v15 offset:40960
    ds_read_b64_tr_b16 a[186:187], v15 offset:45056
    v_mfma_f32_16x16x32_bf16 v[136:139], a[80:83], a[0:3], 0
    ds_read_b128 a[20:23], v8 offset:17408
    v_mfma_f32_16x16x32_bf16 v[176:179], a[84:87], a[0:3], 0
    buffer_store_dwordx4 v[80:83], v21, s[48:51], s38 offen offset:1024 sc1
    v_mfma_f32_16x16x32_bf16 v[156:159], a[80:83], a[4:7], 0
    ds_read_b128 a[24:27], v8 offset:2048
    buffer_load_dwordx2 v[92:93], v254, s[48:51], s34 offen offset:0 sc1
    v_mfma_f32_16x16x32_bf16 v[196:199], a[84:87], a[4:7], 0
    s_waitcnt lgkmcnt(7)
    ds_read_b64_tr_b16 a[188:189], v16 offset:40960
    ds_read_b64_tr_b16 a[190:191], v16 offset:45056
    v_mfma_f32_16x16x32_bf16 v[136:139], a[88:91], a[8:11], v[136:139]
    ds_read_b128 a[28:31], v8 offset:22528
    v_mfma_f32_16x16x32_bf16 v[176:179], a[92:95], a[8:11], v[176:179]
    v_mfma_f32_16x16x32_bf16 v[156:159], a[88:91], a[12:15], v[156:159]
    ds_read_b128 a[32:35], v7 offset:53248
    v_mfma_f32_16x16x32_bf16 v[196:199], a[92:95], a[12:15], v[196:199]
    s_waitcnt lgkmcnt(5)
    v_mfma_f32_16x16x32_bf16 v[136:139], a[96:99], a[16:19], v[136:139]
    ds_read_b128 a[36:39], v8 offset:8192
    v_mfma_f32_16x16x32_bf16 v[176:179], a[100:103], a[16:19], v[176:179]
    v_mfma_f32_16x16x32_bf16 v[156:159], a[96:99], a[20:23], v[156:159]
    ds_read_b128 a[40:43], v7 offset:58368
    v_mfma_f32_16x16x32_bf16 v[196:199], a[100:103], a[20:23], v[196:199]
    s_waitcnt lgkmcnt(3)
    v_mfma_f32_16x16x32_bf16 v[136:139], a[104:107], a[24:27], v[136:139]
    ds_read_b128 a[44:47], v8 offset:13312
    buffer_load_dwordx2 v[94:95], v254, s[48:51], s34 offen offset:0 sc1
    v_mfma_f32_16x16x32_bf16 v[176:179], a[108:111], a[24:27], v[176:179]
    v_mfma_f32_16x16x32_bf16 v[156:159], a[104:107], a[28:31], v[156:159]
    ds_read_b128 a[48:51], v7 offset:63488
    s_waitcnt vmcnt(6)
    s_cmp_lg_u32 s3, 1
    s_cbranch_scc1 L_p1_ok
    s_waitcnt vmcnt(1)
    v_cmp_ne_u64 vcc, v[22:23], v[92:93]
    s_nop 0
    s_cbranch_vccz L_p1_ok
    s_waitcnt vmcnt(0)
    v_cmp_ne_u64 vcc, v[22:23], v[94:95]
    s_nop 0
    s_cbranch_vccnz L_p1_spin
L_p1_ok:
    s_barrier
    s_add_u32 m0, s62, 98304
    s_add_u32 s58, s30, 0
    buffer_load_dwordx4 v21, s[48:51], s58 offen offset:0 sc1 lds
    buffer_load_dwordx4 v21, s[48:51], s58 offen offset:1024 sc1 lds
    s_add_u32 m0, s62, 106496
    s_add_u32 s58, s31, 0
    buffer_load_dwordx4 v21, s[48:51], s58 offen offset:0 sc1 lds
    buffer_load_dwordx4 v21, s[48:51], s58 offen offset:1024 sc1 lds
    s_add_u32 m0, s62, 155648
    s_add_u32 s58, s32, 0
    buffer_load_dwordx4 v21, s[48:51], s58 offen offset:0 sc1 lds
    buffer_load_dwordx4 v21, s[48:51], s58 offen offset:1024 sc1 lds
    v_mfma_f32_16x16x32_bf16 v[196:199], a[108:111], a[28:31], v[196:199]
    s_waitcnt lgkmcnt(3)
    s_add_u32 m0, s62, 49152
    v_mfma_f32_16x16x32_bf16 v[140:143], a[80:83], a[32:35], 0
    s_add_u32 s58, s30, 8192
    ds_read_b128 a[52:55], v8 offset:18432
    buffer_load_dwordx4 v21, s[48:51], s58 offen offset:0 sc1 lds
    v_mfma_f32_16x16x32_bf16 v[180:183], a[84:87], a[32:35], 0
    buffer_load_dwordx4 v21, s[48:51], s58 offen offset:1024 sc1 lds
    v_mfma_f32_16x16x32_bf16 v[160:163], a[80:83], a[36:39], 0
    s_add_u32 m0, s62, 57344
    ds_read_b128 a[56:59], v8 offset:3072
    v_mfma_f32_16x16x32_bf16 v[200:203], a[84:87], a[36:39], 0
    s_waitcnt lgkmcnt(3)
    s_add_u32 s58, s31, 8192
    buffer_load_dwordx4 v21, s[48:51], s58 offen offset:0 sc1 lds
    v_mfma_f32_16x16x32_bf16 v[140:143], a[88:91], a[40:43], v[140:143]
    ds_read_b128 a[60:63], v8 offset:23552
    buffer_load_dwordx4 v21, s[48:51], s58 offen offset:1024 sc1 lds
    s_add_u32 m0, s62, 16384
    s_add_u32 s58, s32, 8192
    buffer_load_dwordx4 v21, s[48:51], s58 offen offset:0 sc1 lds
    buffer_load_dwordx4 v21, s[48:51], s58 offen offset:1024 sc1 lds
    v_mfma_f32_16x16x32_bf16 v[180:183], a[92:95], a[40:43], v[180:183]
    s_waitcnt vmcnt(6)
    s_barrier
    buffer_store_dwordx2 v[22:23], v0, s[48:51], s33 offen offset:8 sc1
    v_mfma_f32_16x16x32_bf16 v[160:163], a[88:91], a[44:47], v[160:163]
    ds_read_b128 a[64:67], v7 offset:32768
    v_mfma_f32_16x16x32_bf16 v[200:203], a[92:95], a[44:47], v[200:203]
    s_waitcnt lgkmcnt(3)
    v_mfma_f32_16x16x32_bf16 v[140:143], a[96:99], a[48:51], v[140:143]
    s_add_u32 m0, s62, 24576
    ds_read_b128 a[68:71], v7 offset:36864
    v_mfma_f32_16x16x32_bf16 v[180:183], a[100:103], a[48:51], v[180:183]
    s_add_u32 s58, s30, 16384
    ds_read_b64_tr_b16 a[192:193], v15 offset:0
    ds_read_b64_tr_b16 a[194:195], v15 offset:4096
    v_mfma_f32_16x16x32_bf16 v[160:163], a[96:99], a[52:55], v[160:163]
    ds_read_b128 a[72:75], v7 offset:33792
    buffer_load_dwordx4 v21, s[48:51], s58 offen offset:0 sc1 lds
    v_mfma_f32_16x16x32_bf16 v[200:203], a[100:103], a[52:55], v[200:203]
    s_waitcnt lgkmcnt(5)
    ds_read_b64_tr_b16 a[196:197], v16 offset:0
    ds_read_b64_tr_b16 a[198:199], v16 offset:4096
    v_mfma_f32_16x16x32_bf16 v[140:143], a[104:107], a[56:59], v[140:143]
    ds_read_b128 a[76:79], v7 offset:37888
    v_mfma_f32_16x16x32_bf16 v[180:183], a[108:111], a[56:59], v[180:183]
    ds_read_b64_tr_b16 a[200:201], v15 offset:8192
    ds_read_b64_tr_b16 a[202:203], v15 offset:12288
    v_mfma_f32_16x16x32_bf16 v[160:163], a[104:107], a[60:63], v[160:163]
    ds_read_b128 a[208:211], v7 offset:34816
    buffer_load_dwordx4 v21, s[48:51], s58 offen offset:1024 sc1 lds
    v_mfma_f32_16x16x32_bf16 v[200:203], a[108:111], a[60:63], v[200:203]
    s_waitcnt lgkmcnt(9)
    s_add_u32 m0, s62, 65536
    ds_read_b64_tr_b16 a[204:205], v16 offset:8192
    ds_read_b64_tr_b16 a[206:207], v16 offset:12288
    v_mfma_f32_16x16x32_bf16 v[124:127], a[112:115], a[64:67], v[124:127]
    s_add_u32 s58, s31, 16384
    ds_read_b128 a[212:215], v7 offset:38912
    v_mfma_f32_16x16x32_bf16 v[164:167], a[116:119], a[64:67], v[164:167]
    v_mfma_f32_16x16x32_bf16 v[144:147], a[112:115], a[68:71], v[144:147]
    ds_read_b128 a[216:219], v7 offset:35840
    buffer_load_dwordx4 v21, s[48:51], s58 offen offset:0 sc1 lds
    v_mfma_f32_16x16x32_bf16 v[184:187], a[116:119], a[68:71], v[184:187]
    s_waitcnt lgkmcnt(7)
    v_mfma_f32_16x16x32_bf16 v[124:127], a[120:123], a[72:75], v[124:127]
    ds_read_b128 a[220:223], v7 offset:39936
    v_mfma_f32_16x16x32_bf16 v[164:167], a[124:127], a[72:75], v[164:167]
    v_mfma_f32_16x16x32_bf16 v[144:147], a[120:123], a[76:79], v[144:147]
    ds_read_b128 a[0:3], v7 offset:40960
    buffer_load_dwordx4 v21, s[48:51], s58 offen offset:1024 sc1 lds
    v_mfma_f32_16x16x32_bf16 v[184:187], a[124:127], a[76:79], v[184:187]
    s_waitcnt lgkmcnt(3)
    s_add_u32 m0, s62, 73728
    v_mfma_f32_16x16x32_bf16 v[124:127], a[128:131], a[208:211], v[124:127]
    s_add_u32 s58, s32, 16384
    ds_read_b128 a[4:7], v7 offset:45056
    v_mfma_f32_16x16x32_bf16 v[164:167], a[132:135], a[208:211], v[164:167]
    s_and_b32 s15, s2, 0xf8
    v_mfma_f32_16x16x32_bf16 v[144:147], a[128:131], a[212:215], v[144:147]
    s_mul_i32 s15, s15, 40960
    ds_read_b128 a[8:11], v7 offset:41984
    buffer_load_dwordx4 v21, s[48:51], s58 offen offset:0 sc1 lds
    v_mfma_f32_16x16x32_bf16 v[184:187], a[132:135], a[212:215], v[184:187]
    s_waitcnt lgkmcnt(3)
    s_and_b32 s16, s52, 3
    v_mfma_f32_16x16x32_bf16 v[124:127], a[136:139], a[216:219], v[124:127]
    s_mul_i32 s17, s16, 2048
    ds_read_b128 a[12:15], v7 offset:46080
    v_mfma_f32_16x16x32_bf16 v[164:167], a[140:143], a[216:219], v[164:167]
    s_add_u32 s15, s15, s17
    v_mfma_f32_16x16x32_bf16 v[144:147], a[136:139], a[220:223], v[144:147]
    s_add_u32 s15, s15, 0xc00000
    ds_read_b128 a[16:19], v7 offset:43008
    buffer_load_dwordx4 v21, s[48:51], s58 offen offset:1024 sc1 lds
    v_mfma_f32_16x16x32_bf16 v[184:187], a[140:143], a[220:223], v[184:187]
    s_waitcnt lgkmcnt(3)
    s_lshl_b32 s17, s3, 4
    v_and_b32 v213, 15, v1
    v_add_u32 v212, s17, v213
    v_mfma_f32_16x16x32_bf16 v[124:127], a[144:147], a[0:3], v[124:127]
    ds_read_b128 a[20:23], v7 offset:47104
    v_lshrrev_b32 v210, 4, v1
    v_mfma_f32_16x16x32_bf16 v[164:167], a[148:151], a[0:3], v[164:167]
    v_mul_u32_u24 v210, 40960, v210
    v_lshl_add_u32 v209, v212, 4, v210
    v_mfma_f32_16x16x32_bf16 v[144:147], a[144:147], a[4:7], v[144:147]
    s_lshr_b32 s60, s52, 2
    ds_read_b128 a[24:27], v7 offset:44032
    v_mfma_f32_16x16x32_bf16 v[184:187], a[148:151], a[4:7], v[184:187]
    s_waitcnt lgkmcnt(3)
    s_lshl_b32 s65, s60, 10
    v_add_u32 v209, s65, v209
    v_lshlrev_b32 v211, 10, v213
    v_mfma_f32_16x16x32_bf16 v[124:127], a[152:155], a[8:11], v[124:127]
    ds_read_b128 a[28:31], v7 offset:48128
    v_and_b32 v212, 16, v1
    v_mfma_f32_16x16x32_bf16 v[164:167], a[156:159], a[8:11], v[164:167]
    v_lshl_add_u32 v211, v212, 1, v211
    v_and_b32 v212, 32, v1
    v_mfma_f32_16x16x32_bf16 v[144:147], a[152:155], a[12:15], v[144:147]
    ds_read_b128 a[32:35], v8 offset:24576
    v_lshl_add_u32 v218, v212, 25, v211
    v_mfma_f32_16x16x32_bf16 v[184:187], a[156:159], a[12:15], v[184:187]
    s_waitcnt lgkmcnt(3)
    v_lshl_add_u32 v211, v212, 9, v211
    v_and_b32 v212, 1, v1
    v_mfma_f32_16x16x32_bf16 v[124:127], a[160:163], a[16:19], v[124:127]
    ds_read_b128 a[36:39], v8 offset:28672
    v_lshlrev_b32 v212, 4, v212
    v_mfma_f32_16x16x32_bf16 v[164:167], a[164:167], a[16:19], v[164:167]
    v_mov_b32 v244, 0x3f80
    v_lshlrev_b32 v212, v212, v244
    v_mfma_f32_16x16x32_bf16 v[144:147], a[160:163], a[20:23], v[144:147]
    ds_read_b128 a[40:43], v8 offset:25600
    v_lshrrev_b32 v213, 1, v213
    buffer_load_dwordx2 v[96:97], v254, s[48:51], s34 offen offset:8 sc1
    v_mfma_f32_16x16x32_bf16 v[184:187], a[164:167], a[20:23], v[184:187]
    s_waitcnt lgkmcnt(3)
    v_cmp_eq_u32 s[28:29], 0, v213
    v_mfma_f32_16x16x32_bf16 v[124:127], a[168:171], a[24:27], v[124:127]
    s_nop 0
    ds_read_b128 a[44:47], v8 offset:29696
    v_cndmask_b32 v244, 0, v212, s[28:29]
    v_mfma_f32_16x16x32_bf16 v[164:167], a[172:175], a[24:27], v[164:167]
    v_cmp_eq_u32 s[28:29], 1, v213
    v_mfma_f32_16x16x32_bf16 v[144:147], a[168:171], a[28:31], v[144:147]
    s_nop 0
    ds_read_b128 a[48:51], v8 offset:26624
    v_cndmask_b32 v245, 0, v212, s[28:29]
    v_mfma_f32_16x16x32_bf16 v[184:187], a[172:175], a[28:31], v[184:187]
    s_waitcnt lgkmcnt(3)
    v_cmp_eq_u32 s[28:29], 2, v213
    v_mfma_f32_16x16x32_bf16 v[124:127], a[176:179], a[32:35], v[124:127]
    s_nop 0
    ds_read_b128 a[52:55], v8 offset:30720
    v_cndmask_b32 v246, 0, v212, s[28:29]
    v_mfma_f32_16x16x32_bf16 v[164:167], a[180:183], a[32:35], v[164:167]
    v_cmp_eq_u32 s[28:29], 3, v213
    v_mfma_f32_16x16x32_bf16 v[144:147], a[176:179], a[36:39], v[144:147]
    s_nop 0
    ds_read_b128 a[56:59], v8 offset:27648
    v_cndmask_b32 v247, 0, v212, s[28:29]
    v_mfma_f32_16x16x32_bf16 v[184:187], a[180:183], a[36:39], v[184:187]
    s_waitcnt lgkmcnt(3)
    v_cmp_eq_u32 s[28:29], 4, v213
    v_mfma_f32_16x16x32_bf16 v[124:127], a[184:187], a[40:43], v[124:127]
    s_nop 0
    ds_read_b128 a[60:63], v8 offset:31744
    v_cndmask_b32 v248, 0, v212, s[28:29]
    v_mfma_f32_16x16x32_bf16 v[164:167], a[188:191], a[40:43], v[164:167]
    s_waitcnt vmcnt(8)
    s_barrier
    v_cmp_eq_u32 s[28:29], 5, v213
    v_mfma_f32_16x16x32_bf16 v[144:147], a[184:187], a[44:47], v[144:147]
    s_nop 0
    ds_read_b128 a[64:67], v21 offset:49152
    v_cndmask_b32 v249, 0, v212, s[28:29]
    v_mfma_f32_16x16x32_bf16 v[184:187], a[188:191], a[44:47], v[184:187]
    s_waitcnt lgkmcnt(3)
    v_cmp_eq_u32 s[28:29], 6, v213
    v_mfma_f32_16x16x32_bf16 v[124:127], a[192:195], a[48:51], v[124:127]
    s_nop 0
    ds_read_b128 a[68:71], v21 offset:53248
    v_cndmask_b32 v250, 0, v212, s[28:29]
    v_mfma_f32_16x16x32_bf16 v[164:167], a[196:199], a[48:51], v[164:167]
    v_cmp_eq_u32 s[28:29], 7, v213
    v_mfma_f32_16x16x32_bf16 v[144:147], a[192:195], a[52:55], v[144:147]
    s_nop 0
    ds_read_b128 a[72:75], v21 offset:50176
    v_cndmask_b32 v251, 0, v212, s[28:29]
    v_mfma_f32_16x16x32_bf16 v[184:187], a[196:199], a[52:55], v[184:187]
    s_waitcnt lgkmcnt(3)
    s_lshl_b32 s16, s16, 6
    v_mfma_f32_16x16x32_bf16 v[124:127], a[200:203], a[56:59], v[124:127]
    s_lshl_b32 s17, s3, 3
    ds_read_b128 a[76:79], v21 offset:54272
    v_mfma_f32_16x16x32_bf16 v[164:167], a[204:207], a[56:59], v[164:167]
    s_add_u32 s16, s16, s17
    v_mfma_f32_16x16x32_bf16 v[144:147], a[200:203], a[60:63], v[144:147]
    s_mul_i32 s60, s60, 81920
    ds_read_b128 a[208:211], v21 offset:51200
    v_mfma_f32_16x16x32_bf16 v[184:187], a[204:207], a[60:63], v[184:187]
    s_waitcnt lgkmcnt(3)
    s_add_u32 s16, s16, s60
    v_mfma_f32_16x16x32_bf16 v[128:131], a[112:115], a[64:67], v[128:131]
    s_mul_i32 s60, s53, 163840
    ds_read_b128 a[212:215], v21 offset:55296
    v_mfma_f32_16x16x32_bf16 v[168:171], a[116:119], a[64:67], v[168:171]
    s_add_u32 s16, s16, s60
    v_mfma_f32_16x16x32_bf16 v[148:151], a[112:115], a[68:71], v[148:151]
    s_lshl_b32 s60, s54, 8
    ds_read_b128 a[216:219], v21 offset:52224
    v_mfma_f32_16x16x32_bf16 v[188:191], a[116:119], a[68:71], v[188:191]
    s_waitcnt lgkmcnt(3)
    s_add_u32 s16, s16, s60
    v_mfma_f32_16x16x32_bf16 v[128:131], a[120:123], a[72:75], v[128:131]
    s_and_b32 s60, s2, 0xf8
    ds_read_b128 a[220:223], v21 offset:56320
    v_or_b32 v214, s60, v1
    v_mfma_f32_16x16x32_bf16 v[168:171], a[124:127], a[72:75], v[168:171]
    s_lshl_b32 s60, s52, 3
    v_lshl_add_u32 v214, v214, 9, s60
    v_lshrrev_b32 v212, 3, v1
    v_mfma_f32_16x16x32_bf16 v[148:151], a[120:123], a[76:79], v[148:151]
    ds_read_b128 a[0:3], v21 offset:57344
    v_or_b32 v212, s3, v212
    v_mfma_f32_16x16x32_bf16 v[188:191], a[124:127], a[76:79], v[188:191]
    s_waitcnt lgkmcnt(3)
    v_min_u32 v212, 1, v212
    v_lshl_add_u32 v214, v212, 30, v214
    v_mfma_f32_16x16x32_bf16 v[128:131], a[128:131], a[208:211], v[128:131]
    ds_read_b128 a[4:7], v21 offset:61440
    v_and_b32 v215, 7, v1
    v_mfma_f32_16x16x32_bf16 v[168:171], a[132:135], a[208:211], v[168:171]
    v_and_b32 v212, 0x40000000, v254
    v_lshl_add_u32 v215, v215, 3, v212
    v_mfma_f32_16x16x32_bf16 v[148:151], a[128:131], a[212:215], v[148:151]
    ds_read_b128 a[8:11], v21 offset:58368
    v_mfma_f32_16x16x32_bf16 v[188:191], a[132:135], a[212:215], v[188:191]
    s_waitcnt lgkmcnt(3)
    v_mfma_f32_16x16x32_bf16 v[128:131], a[136:139], a[216:219], v[128:131]
    ds_read_b128 a[12:15], v21 offset:62464
    v_mfma_f32_16x16x32_bf16 v[168:171], a[140:143], a[216:219], v[168:171]
    v_mfma_f32_16x16x32_bf16 v[148:151], a[136:139], a[220:223], v[148:151]
    ds_read_b128 a[16:19], v21 offset:59392
    s_cmp_lg_u32 s3, 1
    s_cbranch_scc1 L_p2_ok
    s_waitcnt vmcnt(0)
    v_cmp_ne_u64 vcc, v[22:23], v[96:97]
    s_nop 0
    s_cbranch_vccnz L_p2_spin
L_p2_ok:
    s_barrier
    v_mfma_f32_16x16x32_bf16 v[188:191], a[140:143], a[220:223], v[188:191]
    s_waitcnt lgkmcnt(3)
    s_add_u32 m0, s62, 81920
    v_mfma_f32_16x16x32_bf16 v[128:131], a[144:147], a[0:3], v[128:131]
    s_add_u32 s58, s30, 24576
    ds_read_b128 a[20:23], v21 offset:63488
    buffer_load_dwordx4 v21, s[48:51], s58 offen offset:0 sc1 lds
    v_mfma_f32_16x16x32_bf16 v[168:171], a[148:151], a[0:3], v[168:171]
    v_mfma_f32_16x16x32_bf16 v[148:151], a[144:147], a[4:7], v[148:151]
    ds_read_b128 a[24:27], v21 offset:60416
    v_mfma_f32_16x16x32_bf16 v[188:191], a[148:151], a[4:7], v[188:191]
    s_waitcnt lgkmcnt(3)
    buffer_load_dwordx4 v21, s[48:51], s58 offen offset:1024 sc1 lds
    v_mfma_f32_16x16x32_bf16 v[128:131], a[152:155], a[8:11], v[128:131]
    s_add_u32 m0, s62, 90112
    ds_read_b128 a[28:31], v21 offset:64512
    v_mfma_f32_16x16x32_bf16 v[168:171], a[156:159], a[8:11], v[168:171]
    s_add_u32 s58, s31, 24576
    v_mfma_f32_16x16x32_bf16 v[148:151], a[152:155], a[12:15], v[148:151]
    ds_read_b128 a[32:35], v21 offset:16384
    buffer_load_dwordx4 v21, s[48:51], s58 offen offset:0 sc1 lds
    v_mfma_f32_16x16x32_bf16 v[188:191], a[156:159], a[12:15], v[188:191]
    s_waitcnt lgkmcnt(3)
    v_mfma_f32_16x16x32_bf16 v[128:131], a[160:163], a[16:19], v[128:131]
    ds_read_b128 a[36:39], v21 offset:20480
    v_mfma_f32_16x16x32_bf16 v[168:171], a[164:167], a[16:19], v[168:171]
    buffer_load_dwordx4 v21, s[48:51], s58 offen offset:1024 sc1 lds
    v_mfma_f32_16x16x32_bf16 v[148:151], a[160:163], a[20:23], v[148:151]
    s_add_u32 m0, s62, 32768
    ds_read_b128 a[40:43], v21 offset:17408
    v_mfma_f32_16x16x32_bf16 v[188:191], a[164:167], a[20:23], v[188:191]
    s_waitcnt lgkmcnt(3)
    s_add_u32 s58, s32, 24576
    v_mfma_f32_16x16x32_bf16 v[128:131], a[168:171], a[24:27], v[128:131]
    ds_read_b128 a[44:47], v21 offset:21504
    buffer_load_dwordx4 v21, s[48:51], s58 offen offset:0 sc1 lds
    v_mfma_f32_16x16x32_bf16 v[168:171], a[172:175], a[24:27], v[168:171]
    v_mfma_f32_16x16x32_bf16 v[148:151], a[168:171], a[28:31], v[148:151]
    ds_read_b128 a[48:51], v21 offset:18432
    v_mfma_f32_16x16x32_bf16 v[188:191], a[172:175], a[28:31], v[188:191]
    s_waitcnt lgkmcnt(3)
    buffer_load_dwordx4 v21, s[48:51], s58 offen offset:1024 sc1 lds
    v_mfma_f32_16x16x32_bf16 v[128:131], a[176:179], a[32:35], v[128:131]
    ds_read_b128 a[52:55], v21 offset:22528
    v_cvt_pk_bf16_f32 v24, v124, v125
    v_mfma_f32_16x16x32_bf16 v[168:171], a[180:183], a[32:35], v[168:171]
    v_cvt_pk_bf16_f32 v25, v126, v127
    v_cvt_pk_bf16_f32 v26, v164, v165
    v_mfma_f32_16x16x32_bf16 v[148:151], a[176:179], a[36:39], v[148:151]
    ds_read_b128 a[56:59], v21 offset:19456
    v_cvt_pk_bf16_f32 v27, v166, v167
    v_mfma_f32_16x16x32_bf16 v[188:191], a[180:183], a[36:39], v[188:191]
    s_waitcnt lgkmcnt(3)
    s_add_u32 s59, s67, 12582912
    buffer_store_dwordx4 v[24:27], v21, s[48:51], s59 offen offset:0 sc1
    v_mfma_f32_16x16x32_bf16 v[128:131], a[184:187], a[40:43], v[128:131]
    ds_read_b128 a[60:63], v21 offset:23552
    v_cvt_pk_bf16_f32 v28, v144, v145
    v_mfma_f32_16x16x32_bf16 v[168:171], a[188:191], a[40:43], v[168:171]
    s_waitcnt vmcnt(8)
    s_barrier
    v_cvt_pk_bf16_f32 v29, v146, v147
    v_cvt_pk_bf16_f32 v30, v184, v185
    v_mfma_f32_16x16x32_bf16 v[148:151], a[184:187], a[44:47], v[148:151]
    ds_read_b128 a[64:67], v21 offset:24576
    v_cvt_pk_bf16_f32 v31, v186, v187
    v_mfma_f32_16x16x32_bf16 v[188:191], a[188:191], a[44:47], v[188:191]
    s_waitcnt lgkmcnt(3)
    v_mfma_f32_16x16x32_bf16 v[128:131], a[192:195], a[48:51], v[128:131]
    ds_read_b128 a[68:71], v21 offset:28672
    v_mfma_f32_16x16x32_bf16 v[168:171], a[196:199], a[48:51], v[168:171]
    buffer_store_dwordx4 v[28:31], v21, s[48:51], s59 offen offset:1024 sc1
    v_mfma_f32_16x16x32_bf16 v[148:151], a[192:195], a[52:55], v[148:151]
    s_add_u32 m0, s62, 40960
    ds_read_b128 a[72:75], v21 offset:25600
    v_mfma_f32_16x16x32_bf16 v[188:191], a[196:199], a[52:55], v[188:191]
    s_waitcnt lgkmcnt(3)
    s_add_u32 s58, s30, 32768
    buffer_load_dwordx4 v21, s[48:51], s58 offen offset:0 sc1 lds
    v_mfma_f32_16x16x32_bf16 v[128:131], a[200:203], a[56:59], v[128:131]
    ds_read_b128 a[76:79], v21 offset:29696
    v_mfma_f32_16x16x32_bf16 v[168:171], a[204:207], a[56:59], v[168:171]
    v_mfma_f32_16x16x32_bf16 v[148:151], a[200:203], a[60:63], v[148:151]
    ds_read_b128 a[208:211], v21 offset:26624
    buffer_load_dwordx4 v21, s[48:51], s58 offen offset:1024 sc1 lds
    v_mfma_f32_16x16x32_bf16 v[188:191], a[204:207], a[60:63], v[188:191]
    s_waitcnt lgkmcnt(3)
    s_add_u32 m0, s62, 0
    v_mfma_f32_16x16x32_bf16 v[132:135], a[112:115], a[64:67], v[132:135]
    s_add_u32 s58, s31, 32768
    ds_read_b128 a[212:215], v21 offset:30720
    v_mfma_f32_16x16x32_bf16 v[172:175], a[116:119], a[64:67], v[172:175]
    buffer_load_dwordx4 v21, s[48:51], s58 offen offset:0 sc1 lds
    v_mfma_f32_16x16x32_bf16 v[152:155], a[112:115], a[68:71], v[152:155]
    ds_read_b128 a[216:219], v21 offset:27648
    v_mfma_f32_16x16x32_bf16 v[192:195], a[116:119], a[68:71], v[192:195]
    s_waitcnt lgkmcnt(3)
    v_mfma_f32_16x16x32_bf16 v[132:135], a[120:123], a[72:75], v[132:135]
    ds_read_b128 a[220:223], v21 offset:31744
    buffer_load_dwordx4 v21, s[48:51], s58 offen offset:1024 sc1 lds
    v_mfma_f32_16x16x32_bf16 v[172:175], a[124:127], a[72:75], v[172:175]
    s_add_u32 m0, s62, 8192
    v_mfma_f32_16x16x32_bf16 v[152:155], a[120:123], a[76:79], v[152:155]
    s_add_u32 s58, s32, 32768
    ds_read_b128 a[0:3], v7 offset:0
    v_mfma_f32_16x16x32_bf16 v[192:195], a[124:127], a[76:79], v[192:195]
    s_waitcnt lgkmcnt(3)
    buffer_load_dwordx4 v21, s[48:51], s58 offen offset:0 sc1 lds
    v_mfma_f32_16x16x32_bf16 v[132:135], a[128:131], a[208:211], v[132:135]
    ds_read_b128 a[4:7], v7 offset:4096
    v_mfma_f32_16x16x32_bf16 v[172:175], a[132:135], a[208:211], v[172:175]
    v_mfma_f32_16x16x32_bf16 v[152:155], a[128:131], a[212:215], v[152:155]
    ds_read_b128 a[8:11], v7 offset:1024
    buffer_load_dwordx4 v21, s[48:51], s58 offen offset:1024 sc1 lds
    v_mfma_f32_16x16x32_bf16 v[192:195], a[132:135], a[212:215], v[192:195]
    s_waitcnt lgkmcnt(3)
    v_cvt_pk_bf16_f32 v36, v128, v129
    v_cvt_pk_bf16_f32 v37, v130, v131
    v_mfma_f32_16x16x32_bf16 v[132:135], a[136:139], a[216:219], v[132:135]
    ds_read_b128 a[12:15], v7 offset:5120
    v_cvt_pk_bf16_f32 v38, v168, v169
    v_mfma_f32_16x16x32_bf16 v[172:175], a[140:143], a[216:219], v[172:175]
    v_cvt_pk_bf16_f32 v39, v170, v171
    v_mfma_f32_16x16x32_bf16 v[152:155], a[136:139], a[220:223], v[152:155]
    s_add_u32 s59, s67, 12591104
    ds_read_b128 a[16:19], v7 offset:2048
    v_mfma_f32_16x16x32_bf16 v[192:195], a[140:143], a[220:223], v[192:195]
    s_waitcnt lgkmcnt(3)
    buffer_store_dwordx4 v[36:39], v21, s[48:51], s59 offen offset:0 sc1
    v_mfma_f32_16x16x32_bf16 v[132:135], a[144:147], a[0:3], v[132:135]
    ds_read_b128 a[20:23], v7 offset:6144
    v_cvt_pk_bf16_f32 v40, v148, v149
    v_mfma_f32_16x16x32_bf16 v[172:175], a[148:151], a[0:3], v[172:175]
    v_cvt_pk_bf16_f32 v41, v150, v151
    v_cvt_pk_bf16_f32 v42, v188, v189
    v_mfma_f32_16x16x32_bf16 v[152:155], a[144:147], a[4:7], v[152:155]
    ds_read_b128 a[24:27], v7 offset:3072
    v_cvt_pk_bf16_f32 v43, v190, v191
    v_mfma_f32_16x16x32_bf16 v[192:195], a[148:151], a[4:7], v[192:195]
    s_waitcnt lgkmcnt(3)
    v_mfma_f32_16x16x32_bf16 v[132:135], a[152:155], a[8:11], v[132:135]
    ds_read_b128 a[28:31], v7 offset:7168
    v_mfma_f32_16x16x32_bf16 v[172:175], a[156:159], a[8:11], v[172:175]
    buffer_store_dwordx4 v[40:43], v21, s[48:51], s59 offen offset:1024 sc1
    v_mfma_f32_16x16x32_bf16 v[152:155], a[152:155], a[12:15], v[152:155]
    ds_read_b128 a[32:35], v7 offset:8192
    v_mfma_f32_16x16x32_bf16 v[192:195], a[156:159], a[12:15], v[192:195]
    s_waitcnt lgkmcnt(3)
    v_mfma_f32_16x16x32_bf16 v[132:135], a[160:163], a[16:19], v[132:135]
    ds_read_b128 a[36:39], v7 offset:12288
    v_mfma_f32_16x16x32_bf16 v[172:175], a[164:167], a[16:19], v[172:175]
    v_mfma_f32_16x16x32_bf16 v[152:155], a[160:163], a[20:23], v[152:155]
    ds_read_b128 a[40:43], v7 offset:9216
    v_mfma_f32_16x16x32_bf16 v[192:195], a[164:167], a[20:23], v[192:195]
    s_waitcnt lgkmcnt(3)
    v_mfma_f32_16x16x32_bf16 v[132:135], a[168:171], a[24:27], v[132:135]
    ds_read_b128 a[44:47], v7 offset:13312
    v_mfma_f32_16x16x32_bf16 v[172:175], a[172:175], a[24:27], v[172:175]
    v_mfma_f32_16x16x32_bf16 v[152:155], a[168:171], a[28:31], v[152:155]
    ds_read_b128 a[48:51], v7 offset:10240
    v_mfma_f32_16x16x32_bf16 v[192:195], a[172:175], a[28:31], v[192:195]
    s_waitcnt lgkmcnt(3)
    v_mfma_f32_16x16x32_bf16 v[132:135], a[176:179], a[32:35], v[132:135]
    ds_read_b128 a[52:55], v7 offset:14336
    v_mfma_f32_16x16x32_bf16 v[172:175], a[180:183], a[32:35], v[172:175]
    v_mfma_f32_16x16x32_bf16 v[152:155], a[176:179], a[36:39], v[152:155]
    ds_read_b128 a[56:59], v7 offset:11264
    v_mfma_f32_16x16x32_bf16 v[192:195], a[180:183], a[36:39], v[192:195]
    s_waitcnt lgkmcnt(3)
    v_mfma_f32_16x16x32_bf16 v[132:135], a[184:187], a[40:43], v[132:135]
    ds_read_b128 a[60:63], v7 offset:15360
    v_mfma_f32_16x16x32_bf16 v[172:175], a[188:191], a[40:43], v[172:175]
    s_waitcnt vmcnt(10)
    s_barrier
    v_mfma_f32_16x16x32_bf16 v[152:155], a[184:187], a[44:47], v[152:155]
    ds_read_b128 a[64:67], v7 offset:16384
    v_mfma_f32_16x16x32_bf16 v[192:195], a[188:191], a[44:47], v[192:195]
    s_waitcnt lgkmcnt(3)
    v_mfma_f32_16x16x32_bf16 v[132:135], a[192:195], a[48:51], v[132:135]
    ds_read_b128 a[68:71], v7 offset:20480
    v_mfma_f32_16x16x32_bf16 v[172:175], a[196:199], a[48:51], v[172:175]
    v_mfma_f32_16x16x32_bf16 v[152:155], a[192:195], a[52:55], v[152:155]
    ds_read_b128 a[72:75], v7 offset:17408
    v_mfma_f32_16x16x32_bf16 v[192:195], a[196:199], a[52:55], v[192:195]
    s_waitcnt lgkmcnt(3)
    v_mfma_f32_16x16x32_bf16 v[132:135], a[200:203], a[56:59], v[132:135]
    ds_read_b128 a[76:79], v7 offset:21504
    v_mfma_f32_16x16x32_bf16 v[172:175], a[204:207], a[56:59], v[172:175]
    v_mfma_f32_16x16x32_bf16 v[152:155], a[200:203], a[60:63], v[152:155]
    ds_read_b128 a[208:211], v7 offset:18432
    v_mfma_f32_16x16x32_bf16 v[192:195], a[204:207], a[60:63], v[192:195]
    s_waitcnt lgkmcnt(3)
    v_mfma_f32_16x16x32_bf16 v[136:139], a[112:115], a[64:67], v[136:139]
    ds_read_b128 a[212:215], v7 offset:22528
    v_mfma_f32_16x16x32_bf16 v[176:179], a[116:119], a[64:67], v[176:179]
    v_mfma_f32_16x16x32_bf16 v[156:159], a[112:115], a[68:71], v[156:159]
    ds_read_b128 a[216:219], v7 offset:19456
    v_mfma_f32_16x16x32_bf16 v[196:199], a[116:119], a[68:71], v[196:199]
    s_waitcnt lgkmcnt(3)
    v_mfma_f32_16x16x32_bf16 v[136:139], a[120:123], a[72:75], v[136:139]
    ds_read_b128 a[220:223], v7 offset:23552
    v_mfma_f32_16x16x32_bf16 v[176:179], a[124:127], a[72:75], v[176:179]
    v_cvt_pk_bf16_f32 v24, v132, v133
    v_cvt_pk_bf16_f32 v25, v134, v135
    v_mfma_f32_16x16x32_bf16 v[156:159], a[120:123], a[76:79], v[156:159]
    ds_read_b128 a[0:3], v7 offset:24576
    v_cvt_pk_bf16_f32 v26, v172, v173
    v_mfma_f32_16x16x32_bf16 v[196:199], a[124:127], a[76:79], v[196:199]
    s_waitcnt lgkmcnt(3)
    v_cvt_pk_bf16_f32 v27, v174, v175
    v_mfma_f32_16x16x32_bf16 v[136:139], a[128:131], a[208:211], v[136:139]
    s_add_u32 s59, s67, 12599296
    ds_read_b128 a[4:7], v7 offset:28672
    v_mfma_f32_16x16x32_bf16 v[176:179], a[132:135], a[208:211], v[176:179]
    buffer_store_dwordx4 v[24:27], v21, s[48:51], s59 offen offset:0 sc1
    v_mfma_f32_16x16x32_bf16 v[156:159], a[128:131], a[212:215], v[156:159]
    ds_read_b128 a[8:11], v7 offset:25600
    v_cvt_pk_bf16_f32 v28, v152, v153
    v_mfma_f32_16x16x32_bf16 v[196:199], a[132:135], a[212:215], v[196:199]
    s_waitcnt lgkmcnt(3)
    v_cvt_pk_bf16_f32 v29, v154, v155
    v_cvt_pk_bf16_f32 v30, v192, v193
    v_mfma_f32_16x16x32_bf16 v[136:139], a[136:139], a[216:219], v[136:139]
    ds_read_b128 a[12:15], v7 offset:29696
    v_cvt_pk_bf16_f32 v31, v194, v195
    v_mfma_f32_16x16x32_bf16 v[176:179], a[140:143], a[216:219], v[176:179]
    v_mfma_f32_16x16x32_bf16 v[156:159], a[136:139], a[220:223], v[156:159]
    ds_read_b128 a[16:19], v7 offset:26624
    v_mfma_f32_16x16x32_bf16 v[196:199], a[140:143], a[220:223], v[196:199]
    s_waitcnt lgkmcnt(3)
    buffer_store_dwordx4 v[28:31], v21, s[48:51], s59 offen offset:1024 sc1
    v_mfma_f32_16x16x32_bf16 v[136:139], a[144:147], a[0:3], v[136:139]
    ds_read_b128 a[20:23], v7 offset:30720
    v_mfma_f32_16x16x32_bf16 v[176:179], a[148:151], a[0:3], v[176:179]
    v_mfma_f32_16x16x32_bf16 v[156:159], a[144:147], a[4:7], v[156:159]
    ds_read_b128 a[24:27], v7 offset:27648
    v_mfma_f32_16x16x32_bf16 v[196:199], a[148:151], a[4:7], v[196:199]
    s_waitcnt lgkmcnt(3)
    v_mfma_f32_16x16x32_bf16 v[136:139], a[152:155], a[8:11], v[136:139]
    ds_read_b128 a[28:31], v7 offset:31744
    v_mfma_f32_16x16x32_bf16 v[176:179], a[156:159], a[8:11], v[176:179]
    v_mfma_f32_16x16x32_bf16 v[156:159], a[152:155], a[12:15], v[156:159]
    ds_read_b128 a[32:35], v21 offset:32768
    v_mfma_f32_16x16x32_bf16 v[196:199], a[156:159], a[12:15], v[196:199]
    s_waitcnt lgkmcnt(3)
    v_mfma_f32_16x16x32_bf16 v[136:139], a[160:163], a[16:19], v[136:139]
    ds_read_b128 a[36:39], v21 offset:36864
    v_mfma_f32_16x16x32_bf16 v[176:179], a[164:167], a[16:19], v[176:179]
    v_mfma_f32_16x16x32_bf16 v[156:159], a[160:163], a[20:23], v[156:159]
    ds_read_b128 a[40:43], v21 offset:33792
    v_mfma_f32_16x16x32_bf16 v[196:199], a[164:167], a[20:23], v[196:199]
    s_waitcnt lgkmcnt(3)
    v_mfma_f32_16x16x32_bf16 v[136:139], a[168:171], a[24:27], v[136:139]
    ds_read_b128 a[44:47], v21 offset:37888
    v_mfma_f32_16x16x32_bf16 v[176:179], a[172:175], a[24:27], v[176:179]
    v_mfma_f32_16x16x32_bf16 v[156:159], a[168:171], a[28:31], v[156:159]
    ds_read_b128 a[48:51], v21 offset:34816
    v_mfma_f32_16x16x32_bf16 v[196:199], a[172:175], a[28:31], v[196:199]
    s_waitcnt lgkmcnt(3)
    v_mfma_f32_16x16x32_bf16 v[136:139], a[176:179], a[32:35], v[136:139]
    ds_read_b128 a[52:55], v21 offset:38912
    v_mfma_f32_16x16x32_bf16 v[176:179], a[180:183], a[32:35], v[176:179]
    v_mfma_f32_16x16x32_bf16 v[156:159], a[176:179], a[36:39], v[156:159]
    ds_read_b128 a[56:59], v21 offset:35840
    v_mfma_f32_16x16x32_bf16 v[196:199], a[180:183], a[36:39], v[196:199]
    s_waitcnt lgkmcnt(3)
    v_mfma_f32_16x16x32_bf16 v[136:139], a[184:187], a[40:43], v[136:139]
    ds_read_b128 a[60:63], v21 offset:39936
    v_mfma_f32_16x16x32_bf16 v[176:179], a[188:191], a[40:43], v[176:179]
    s_waitcnt vmcnt(4)
    s_barrier
    v_mfma_f32_16x16x32_bf16 v[156:159], a[184:187], a[44:47], v[156:159]
    ds_read_b128 a[64:67], v21 offset:40960
    v_mfma_f32_16x16x32_bf16 v[196:199], a[188:191], a[44:47], v[196:199]
    s_waitcnt lgkmcnt(3)
    v_mfma_f32_16x16x32_bf16 v[136:139], a[192:195], a[48:51], v[136:139]
    ds_read_b128 a[68:71], v21 offset:45056
    v_mfma_f32_16x16x32_bf16 v[176:179], a[196:199], a[48:51], v[176:179]
    v_mfma_f32_16x16x32_bf16 v[156:159], a[192:195], a[52:55], v[156:159]
    ds_read_b128 a[72:75], v21 offset:41984
    v_mfma_f32_16x16x32_bf16 v[196:199], a[196:199], a[52:55], v[196:199]
    s_waitcnt lgkmcnt(3)
    v_mfma_f32_16x16x32_bf16 v[136:139], a[200:203], a[56:59], v[136:139]
    ds_read_b128 a[76:79], v21 offset:46080
    v_mfma_f32_16x16x32_bf16 v[176:179], a[204:207], a[56:59], v[176:179]
    v_mfma_f32_16x16x32_bf16 v[156:159], a[200:203], a[60:63], v[156:159]
    ds_read_b128 a[208:211], v21 offset:43008
    v_mfma_f32_16x16x32_bf16 v[196:199], a[204:207], a[60:63], v[196:199]
    s_waitcnt lgkmcnt(3)
    v_mfma_f32_16x16x32_bf16 v[140:143], a[112:115], a[64:67], v[140:143]
    ds_read_b128 a[212:215], v21 offset:47104
    v_mfma_f32_16x16x32_bf16 v[180:183], a[116:119], a[64:67], v[180:183]
    v_mfma_f32_16x16x32_bf16 v[160:163], a[112:115], a[68:71], v[160:163]
    ds_read_b128 a[216:219], v21 offset:44032
    v_mfma_f32_16x16x32_bf16 v[200:203], a[116:119], a[68:71], v[200:203]
    s_waitcnt lgkmcnt(3)
    v_mfma_f32_16x16x32_bf16 v[140:143], a[120:123], a[72:75], v[140:143]
    ds_read_b128 a[220:223], v21 offset:48128
    v_mfma_f32_16x16x32_bf16 v[180:183], a[124:127], a[72:75], v[180:183]
    v_cvt_pk_bf16_f32 v36, v136, v137
    v_cvt_pk_bf16_f32 v37, v138, v139
    v_mfma_f32_16x16x32_bf16 v[160:163], a[120:123], a[76:79], v[160:163]
    ds_read_b128 a[0:3], v21 offset:0
    v_cvt_pk_bf16_f32 v38, v176, v177
    v_mfma_f32_16x16x32_bf16 v[200:203], a[124:127], a[76:79], v[200:203]
    s_waitcnt lgkmcnt(3)
    v_cvt_pk_bf16_f32 v39, v178, v179
    v_mfma_f32_16x16x32_bf16 v[140:143], a[128:131], a[208:211], v[140:143]
    s_add_u32 s59, s67, 12607488
    ds_read_b128 a[4:7], v21 offset:4096
    v_mfma_f32_16x16x32_bf16 v[180:183], a[132:135], a[208:211], v[180:183]
    buffer_store_dwordx4 v[36:39], v21, s[48:51], s59 offen offset:0 sc1
    v_mfma_f32_16x16x32_bf16 v[160:163], a[128:131], a[212:215], v[160:163]
    ds_read_b128 a[8:11], v21 offset:1024
    v_cvt_pk_bf16_f32 v40, v156, v157
    v_mfma_f32_16x16x32_bf16 v[200:203], a[132:135], a[212:215], v[200:203]
    s_waitcnt lgkmcnt(3)
    v_cvt_pk_bf16_f32 v41, v158, v159
    v_cvt_pk_bf16_f32 v42, v196, v197
    v_mfma_f32_16x16x32_bf16 v[140:143], a[136:139], a[216:219], v[140:143]
    ds_read_b128 a[12:15], v21 offset:5120
    v_cvt_pk_bf16_f32 v43, v198, v199
    v_mfma_f32_16x16x32_bf16 v[180:183], a[140:143], a[216:219], v[180:183]
    v_mfma_f32_16x16x32_bf16 v[160:163], a[136:139], a[220:223], v[160:163]
    ds_read_b128 a[16:19], v21 offset:2048
    v_mfma_f32_16x16x32_bf16 v[200:203], a[140:143], a[220:223], v[200:203]
    s_waitcnt lgkmcnt(3)
    buffer_store_dwordx4 v[40:43], v21, s[48:51], s59 offen offset:1024 sc1
    v_mfma_f32_16x16x32_bf16 v[140:143], a[144:147], a[0:3], v[140:143]
    ds_read_b128 a[20:23], v21 offset:6144
    v_mfma_f32_16x16x32_bf16 v[180:183], a[148:151], a[0:3], v[180:183]
    v_mfma_f32_16x16x32_bf16 v[160:163], a[144:147], a[4:7], v[160:163]
    ds_read_b128 a[24:27], v21 offset:3072
    v_mfma_f32_16x16x32_bf16 v[200:203], a[148:151], a[4:7], v[200:203]
    s_waitcnt lgkmcnt(3)
    v_mfma_f32_16x16x32_bf16 v[140:143], a[152:155], a[8:11], v[140:143]
    ds_read_b128 a[28:31], v21 offset:7168
    v_mfma_f32_16x16x32_bf16 v[180:183], a[156:159], a[8:11], v[180:183]
    v_mfma_f32_16x16x32_bf16 v[160:163], a[152:155], a[12:15], v[160:163]
    ds_read_b128 a[32:35], v21 offset:8192
    v_mfma_f32_16x16x32_bf16 v[200:203], a[156:159], a[12:15], v[200:203]
    s_waitcnt lgkmcnt(3)
    v_mfma_f32_16x16x32_bf16 v[140:143], a[160:163], a[16:19], v[140:143]
    ds_read_b128 a[36:39], v21 offset:12288
    v_mfma_f32_16x16x32_bf16 v[180:183], a[164:167], a[16:19], v[180:183]
    v_mfma_f32_16x16x32_bf16 v[160:163], a[160:163], a[20:23], v[160:163]
    ds_read_b128 a[40:43], v21 offset:9216
    v_mfma_f32_16x16x32_bf16 v[200:203], a[164:167], a[20:23], v[200:203]
    s_waitcnt lgkmcnt(3)
    v_mfma_f32_16x16x32_bf16 v[140:143], a[168:171], a[24:27], v[140:143]
    ds_read_b128 a[44:47], v21 offset:13312
    s_waitcnt vmcnt(2)
    s_barrier
    buffer_store_dwordx2 v[22:23], v214, s[48:51], s33 offen offset:128 sc1
    v_mfma_f32_16x16x32_bf16 v[180:183], a[172:175], a[24:27], v[180:183]
    v_mfma_f32_16x16x32_bf16 v[160:163], a[168:171], a[28:31], v[160:163]
    ds_read_b128 a[48:51], v21 offset:10240
    v_mfma_f32_16x16x32_bf16 v[200:203], a[172:175], a[28:31], v[200:203]
    s_waitcnt lgkmcnt(3)
    v_mfma_f32_16x16x32_bf16 v[140:143], a[176:179], a[32:35], v[140:143]
    ds_read_b128 a[52:55], v21 offset:14336
    v_mfma_f32_16x16x32_bf16 v[180:183], a[180:183], a[32:35], v[180:183]
    v_mfma_f32_16x16x32_bf16 v[160:163], a[176:179], a[36:39], v[160:163]
    ds_read_b128 a[56:59], v21 offset:11264
    v_mfma_f32_16x16x32_bf16 v[200:203], a[180:183], a[36:39], v[200:203]
    s_waitcnt lgkmcnt(3)
    v_mfma_f32_16x16x32_bf16 v[140:143], a[184:187], a[40:43], v[140:143]
    ds_read_b128 a[60:63], v21 offset:15360
    v_mfma_f32_16x16x32_bf16 v[180:183], a[188:191], a[40:43], v[180:183]
    v_mfma_f32_16x16x32_bf16 v[160:163], a[184:187], a[44:47], v[160:163]
    v_mfma_f32_16x16x32_bf16 v[200:203], a[188:191], a[44:47], v[200:203]
    s_waitcnt lgkmcnt(2)
    v_mfma_f32_16x16x32_bf16 v[140:143], a[192:195], a[48:51], v[140:143]
    v_mfma_f32_16x16x32_bf16 v[180:183], a[196:199], a[48:51], v[180:183]
    v_mfma_f32_16x16x32_bf16 v[160:163], a[192:195], a[52:55], v[160:163]
    v_mfma_f32_16x16x32_bf16 v[200:203], a[196:199], a[52:55], v[200:203]
    s_waitcnt lgkmcnt(0)
    v_mfma_f32_16x16x32_bf16 v[140:143], a[200:203], a[56:59], v[140:143]
    v_mfma_f32_16x16x32_bf16 v[180:183], a[204:207], a[56:59], v[180:183]
    v_mfma_f32_16x16x32_bf16 v[160:163], a[200:203], a[60:63], v[160:163]
    buffer_load_dwordx2 v[102:103], v215, s[48:51], s34 offen offset:128 sc1
    v_mfma_f32_16x16x32_bf16 v[200:203], a[204:207], a[60:63], v[200:203]
    s_nop 3
    v_cvt_pk_bf16_f32 v24, v140, v141
    v_cvt_pk_bf16_f32 v25, v142, v143
    v_cvt_pk_bf16_f32 v26, v180, v181
    v_cvt_pk_bf16_f32 v27, v182, v183
    s_add_u32 s59, s67, 12615680
    buffer_store_dwordx4 v[24:27], v21, s[48:51], s59 offen offset:0 sc1
    v_cvt_pk_bf16_f32 v28, v160, v161
    v_cvt_pk_bf16_f32 v29, v162, v163
    v_cvt_pk_bf16_f32 v30, v200, v201
    v_cvt_pk_bf16_f32 v31, v202, v203
    buffer_store_dwordx4 v[28:31], v21, s[48:51], s59 offen offset:1024 sc1
    s_waitcnt vmcnt(0)
    s_barrier
    buffer_store_dwordx2 v[22:23], v214, s[48:51], s33 offen offset:256 sc1
    s_cmp_lg_u32 s3, 1
    s_cbranch_scc1 L_ca_ok
    v_cmp_ne_u64 vcc, v[22:23], v[102:103]
    s_nop 0
    s_cbranch_vccnz L_ca_spin
L_ca_ok:
    s_barrier
    s_add_u32 s14, s15, 0
    buffer_load_dwordx4 v[224:227], v209, s[48:51], s14 offen sc1
    s_add_u32 s14, s15, 163840
    buffer_load_dwordx4 v[228:231], v209, s[48:51], s14 offen sc1
    s_add_u32 s14, s15, 8192
    buffer_load_dwordx4 v[234:237], v209, s[48:51], s14 offen sc1
    s_add_u32 s14, s15, 172032
    buffer_load_dwordx4 v[238:241], v209, s[48:51], s14 offen sc1
    s_add_u32 s14, s15, 16384
    buffer_load_dwordx4 v[64:67], v209, s[48:51], s14 offen sc1
    s_add_u32 s14, s15, 180224
    buffer_load_dwordx4 v[68:71], v209, s[48:51], s14 offen sc1
    buffer_load_dwordx2 v[104:105], v215, s[48:51], s34 offen offset:256 sc1
    s_cmp_lg_u32 s3, 1
    s_cbranch_scc1 L_cb_ok
    s_waitcnt vmcnt(0)
    v_cmp_ne_u64 vcc, v[22:23], v[104:105]
    s_nop 0
    s_cbranch_vccnz L_cb_spin
L_cb_ok:
    s_barrier
    s_add_u32 s14, s15, 24576
    buffer_load_dwordx4 v[74:77], v209, s[48:51], s14 offen sc1
    s_add_u32 s14, s15, 188416
    buffer_load_dwordx4 v[78:81], v209, s[48:51], s14 offen sc1
    s_add_u32 s14, s15, 32768
    buffer_load_dwordx4 v[48:51], v209, s[48:51], s14 offen sc1
    s_add_u32 s14, s15, 196608
    buffer_load_dwordx4 v[52:55], v209, s[48:51], s14 offen sc1
    s_waitcnt vmcnt(0)
    v_mfma_f32_16x16x32_bf16 v[124:127], v[244:247], v[224:227], 0
    v_mfma_f32_16x16x32_bf16 v[128:131], v[244:247], v[64:67], 0
    v_mfma_f32_16x16x32_bf16 v[132:135], v[244:247], v[48:51], 0
    v_mfma_f32_16x16x32_bf16 v[124:127], v[248:251], v[234:237], v[124:127]
    v_mfma_f32_16x16x32_bf16 v[128:131], v[248:251], v[74:77], v[128:131]
    v_mfma_f32_16x16x32_bf16 v[132:135], v[244:247], v[52:55], v[132:135]
    v_mfma_f32_16x16x32_bf16 v[124:127], v[244:247], v[228:231], v[124:127]
    v_mfma_f32_16x16x32_bf16 v[128:131], v[244:247], v[68:71], v[128:131]
    v_mfma_f32_16x16x32_bf16 v[124:127], v[248:251], v[238:241], v[124:127]
    v_mfma_f32_16x16x32_bf16 v[128:131], v[248:251], v[78:81], v[128:131]
    s_add_u32 s59, s16, 65536
    s_nop 2
    v_cvt_pk_bf16_f32 v144, v132, v133
    v_cvt_pk_bf16_f32 v145, v134, v135
    buffer_store_dwordx2 v[144:145], v218, s[40:43], s59 offen
    s_add_u32 s59, s16, 0
    v_cvt_pk_bf16_f32 v140, v124, v125
    v_cvt_pk_bf16_f32 v141, v126, v127
    buffer_store_dwordx2 v[140:141], v211, s[40:43], s59 offen
    s_add_u32 s59, s16, 32768
    v_cvt_pk_bf16_f32 v142, v128, v129
    v_cvt_pk_bf16_f32 v143, v130, v131
    buffer_store_dwordx2 v[142:143], v211, s[40:43], s59 offen
L_end:
    s_endpgm
L_p1_spin:
    s_mov_b32 s64, 0
L_p1_loop:
    buffer_load_dwordx2 v[94:95], v254, s[48:51], s34 offen offset:0 sc1
    s_waitcnt vmcnt(0)
    v_cmp_ne_u64 vcc, v[22:23], v[94:95]
    s_nop 0
    s_cbranch_vccz L_p1_ok
    s_add_u32 s64, s64, 1
    s_cmp_lt_u32 s64, 400000
    s_cbranch_scc1 L_p1_loop
    s_branch L_p1_ok
L_p2_spin:
    s_mov_b32 s64, 0
L_p2_loop:
    buffer_load_dwordx2 v[96:97], v254, s[48:51], s34 offen offset:8 sc1
    s_waitcnt vmcnt(0)
    v_cmp_ne_u64 vcc, v[22:23], v[96:97]
    s_nop 0
    s_cbranch_vccz L_p2_ok
    s_add_u32 s64, s64, 1
    s_cmp_lt_u32 s64, 400000
    s_cbranch_scc1 L_p2_loop
    s_branch L_p2_ok
L_ca_spin:
    s_mov_b32 s64, 0
L_ca_loop:
    buffer_load_dwordx2 v[102:103], v215, s[48:51], s34 offen offset:128 sc1
    s_waitcnt vmcnt(0)
    v_cmp_ne_u64 vcc, v[22:23], v[102:103]
    s_nop 0
    s_cbranch_vccz L_ca_ok
    s_add_u32 s64, s64, 1
    s_cmp_lt_u32 s64, 400000
    s_cbranch_scc1 L_ca_loop
    s_branch L_ca_ok
L_cb_spin:
    s_mov_b32 s64, 0
L_cb_loop:
    buffer_load_dwordx2 v[104:105], v215, s[48:51], s34 offen offset:256 sc1
    s_waitcnt vmcnt(0)
    v_cmp_ne_u64 vcc, v[22:23], v[104:105]
    s_nop 0
    s_cbranch_vccz L_cb_ok
    s_add_u32 s64, s64, 1
    s_cmp_lt_u32 s64, 400000
    s_cbranch_scc1 L_cb_loop
    s_branch L_cb_ok
L_nonce_slow:
    s_mov_b32 s65, 0
    v_mov_b32 v244, 0
L_nonce_spin:
    buffer_load_dwordx2 v[22:23], v244, s[44:47], 0 offen sc1
    s_waitcnt vmcnt(0)
    v_readfirstlane_b32 s4, v22
    v_readfirstlane_b32 s5, v23
    s_and_b32 s58, s4, 1
    s_lshr_b32 s59, s5, 31
    s_and_b32 s58, s58, s59
    s_cbranch_scc1 L_nonce_ok
    s_add_u32 s65, s65, 1
    s_cmp_lt_u32 s65, 400000
    s_cbranch_scc1 L_nonce_spin
    s_branch L_nonce_ok
L_fallback:
    s_cmp_lg_u32 s64, 0
    s_cbranch_scc1 L_nofb
    s_mov_b32 s64, 1
    s_waitcnt vmcnt(0) lgkmcnt(0)
    s_barrier
    s_nop 7
    v_mov_b32 v224, 0xff800000
    v_mov_b32 v225, 0xff800000
    v_mov_b32 v226, 0xff800000
    v_mov_b32 v227, 0xff800000
    v_mov_b32 v228, 0xff800000
    s_lshl_b32 s58, s55, 11
    v_subrev_u32 v232, s58, v7
    v_subrev_u32 v233, s58, v8
    v_subrev_u32 v234, s58, v9
    v_subrev_u32 v235, s58, v10
    s_mov_b32 s65, 0
L_fb_loop:
    s_add_u32 m0, s61, 0
    s_nop 0
    buffer_load_dwordx4 v2, s[24:27], s65 offen offset:0 lds
    buffer_load_dwordx4 v2, s[24:27], s65 offen offset:1024 lds
    buffer_load_dwordx4 v2, s[24:27], s65 offen offset:2048 lds
    buffer_load_dwordx4 v2, s[24:27], s65 offen offset:3072 lds
    s_waitcnt vmcnt(0)
    s_barrier
    s_mov_b32 s59, 0
L_fb_kt:
    v_add_u32 v236, s59, v232
    v_add_u32 v237, s59, v233
    v_add_u32 v238, s59, v234
    v_add_u32 v239, s59, v235
    ds_read_b128 a[240:243], v236 offset:0
    ds_read_b128 a[244:247], v237 offset:0
    ds_read_b128 a[248:251], v238 offset:0
    ds_read_b128 a[252:255], v239 offset:0
    s_waitcnt lgkmcnt(0)
    v_mfma_f32_16x16x32_bf16 v[44:47], a[240:243], v[84:87], 0
    v_mfma_f32_16x16x32_bf16 v[48:51], a[240:243], v[88:91], 0
    v_mfma_f32_16x16x32_bf16 v[52:55], a[240:243], v[92:95], 0
    v_mfma_f32_16x16x32_bf16 v[56:59], a[240:243], v[96:99], 0
    v_mfma_f32_16x16x32_bf16 v[60:63], a[240:243], v[100:103], 0
    v_mfma_f32_16x16x32_bf16 v[44:47], a[244:247], v[104:107], v[44:47]
    v_mfma_f32_16x16x32_bf16 v[48:51], a[244:247], v[108:111], v[48:51]
    v_mfma_f32_16x16x32_bf16 v[52:55], a[244:247], v[112:115], v[52:55]
    v_mfma_f32_16x16x32_bf16 v[56:59], a[244:247], v[116:119], v[56:59]
    v_mfma_f32_16x16x32_bf16 v[60:63], a[244:247], v[120:123], v[60:63]
    v_mfma_f32_16x16x32_bf16 v[64:67], a[248:251], a[40:43], 0
    v_mfma_f32_16x16x32_bf16 v[68:71], a[248:251], a[44:47], 0
    v_mfma_f32_16x16x32_bf16 v[72:75], a[248:251], a[48:51], 0
    v_mfma_f32_16x16x32_bf16 v[76:79], a[248:251], a[52:55], 0
    v_mfma_f32_16x16x32_bf16 v[80:83], a[248:251], a[56:59], 0
    v_mfma_f32_16x16x32_bf16 v[64:67], a[252:255], a[60:63], v[64:67]
    v_mfma_f32_16x16x32_bf16 v[68:71], a[252:255], a[64:67], v[68:71]
    v_mfma_f32_16x16x32_bf16 v[72:75], a[252:255], a[68:71], v[72:75]
    v_mfma_f32_16x16x32_bf16 v[76:79], a[252:255], a[72:75], v[76:79]
    v_mfma_f32_16x16x32_bf16 v[80:83], a[252:255], a[76:79], v[80:83]
    s_nop 3
    v_add_f32 v44, v44, v64
    v_add_f32 v45, v45, v65
    v_add_f32 v46, v46, v66
    v_add_f32 v47, v47, v67
    v_add_f32 v48, v48, v68
    v_add_f32 v49, v49, v69
    v_add_f32 v50, v50, v70
    v_add_f32 v51, v51, v71
    v_add_f32 v52, v52, v72
    v_add_f32 v53, v53, v73
    v_add_f32 v54, v54, v74
    v_add_f32 v55, v55, v75
    v_add_f32 v56, v56, v76
    v_add_f32 v57, v57, v77
    v_add_f32 v58, v58, v78
    v_add_f32 v59, v59, v79
    v_add_f32 v60, v60, v80
    v_add_f32 v61, v61, v81
    v_add_f32 v62, v62, v82
    v_add_f32 v63, v63, v83
    v_max3_f32 v224, v224, v44, v45
    v_max3_f32 v224, v224, v46, v47
    v_max3_f32 v225, v225, v48, v49
    v_max3_f32 v225, v225, v50, v51
    v_max3_f32 v226, v226, v52, v53
    v_max3_f32 v226, v226, v54, v55
    v_max3_f32 v227, v227, v56, v57
    v_max3_f32 v227, v227, v58, v59
    v_max3_f32 v228, v228, v60, v61
    v_max3_f32 v228, v228, v62, v63
    s_add_u32 s59, s59, 1024
    s_cmp_lt_u32 s59, 4096
    s_cbranch_scc1 L_fb_kt
    s_barrier
    s_add_u32 s65, s65, 16384
    s_cmp_lt_u32 s65, 131072
    s_cbranch_scc1 L_fb_loop
    v_mov_b32 v249, v224
    v_mov_b32 v250, v225
    v_mov_b32 v251, v226
    v_mov_b32 v252, v227
    v_mov_b32 v253, v228
    v_permlane16_swap_b32 v224, v249
    v_permlane16_swap_b32 v225, v250
    v_permlane16_swap_b32 v226, v251
    v_permlane16_swap_b32 v227, v252
    v_permlane16_swap_b32 v228, v253
    v_max_f32 v224, v224, v249
    v_max_f32 v225, v225, v250
    v_max_f32 v226, v226, v251
    v_max_f32 v227, v227, v252
    v_max_f32 v228, v228, v253
    v_mov_b32 v249, v224
    v_mov_b32 v250, v225
    v_mov_b32 v251, v226
    v_mov_b32 v252, v227
    v_mov_b32 v253, v228
    v_permlane32_swap_b32 v224, v249
    v_permlane32_swap_b32 v225, v250
    v_permlane32_swap_b32 v226, v251
    v_permlane32_swap_b32 v227, v252
    v_permlane32_swap_b32 v228, v253
    v_max_f32 v224, v224, v249
    v_max_f32 v225, v225, v250
    v_max_f32 v226, v226, v251
    v_max_f32 v227, v227, v252
    v_max_f32 v228, v228, v253
    v_sub_f32 v204, 0, v224
    v_sub_f32 v205, 0, v224
    v_sub_f32 v206, 0, v224
    v_sub_f32 v207, 0, v224
    v_sub_f32 v208, 0, v225
    v_sub_f32 v209, 0, v225
    v_sub_f32 v210, 0, v225
    v_sub_f32 v211, 0, v225
    v_sub_f32 v212, 0, v226
    v_sub_f32 v213, 0, v226
    v_sub_f32 v214, 0, v226
    v_sub_f32 v215, 0, v226
    v_sub_f32 v216, 0, v227
    v_sub_f32 v217, 0, v227
    v_sub_f32 v218, 0, v227
    v_sub_f32 v219, 0, v227
    v_sub_f32 v220, 0, v228
    v_sub_f32 v221, 0, v228
    v_sub_f32 v222, 0, v228
    v_sub_f32 v223, 0, v228
    s_add_u32 m0, s61, 0
    s_mov_b32 s58, 0
    buffer_load_dwordx4 v2, s[24:27], s58 offen offset:0 nt lds
    buffer_load_dwordx4 v2, s[24:27], s58 offen offset:1024 nt lds
    buffer_load_dwordx4 v2, s[24:27], s58 offen offset:2048 nt lds
    buffer_load_dwordx4 v2, s[24:27], s58 offen offset:3072 nt lds
    s_add_u32 m0, s61, 16384
    s_mov_b32 s58, 16384
    buffer_load_dwordx4 v2, s[24:27], s58 offen offset:0 nt lds
    buffer_load_dwordx4 v2, s[24:27], s58 offen offset:1024 nt lds
    buffer_load_dwordx4 v2, s[24:27], s58 offen offset:2048 nt lds
    buffer_load_dwordx4 v2, s[24:27], s58 offen offset:3072 nt lds
    s_add_u32 m0, s61, 32768
    s_mov_b32 s58, 32768
    buffer_load_dwordx4 v2, s[24:27], s58 offen offset:0 nt lds
    buffer_load_dwordx4 v2, s[24:27], s58 offen offset:1024 nt lds
    buffer_load_dwordx4 v2, s[24:27], s58 offen offset:2048 nt lds
    buffer_load_dwordx4 v2, s[24:27], s58 offen offset:3072 nt lds
    s_add_u32 m0, s61, 49152
    s_mov_b32 s58, 0
    buffer_load_dwordx4 v3, s[28:31], s58 offen offset:0 nt lds
    buffer_load_dwordx4 v3, s[28:31], s58 offen offset:1024 nt lds
    buffer_load_dwordx4 v3, s[28:31], s58 offen offset:2048 nt lds
    buffer_load_dwordx4 v3, s[28:31], s58 offen offset:3072 nt lds
    s_add_u32 m0, s61, 65536
    s_mov_b32 s58, 16384
    buffer_load_dwordx4 v3, s[28:31], s58 offen offset:0 nt lds
    buffer_load_dwordx4 v3, s[28:31], s58 offen offset:1024 nt lds
    buffer_load_dwordx4 v3, s[28:31], s58 offen offset:2048 nt lds
    buffer_load_dwordx4 v3, s[28:31], s58 offen offset:3072 nt lds
    s_add_u32 m0, s61, 81920
    s_mov_b32 s58, 32768
    buffer_load_dwordx4 v3, s[28:31], s58 offen offset:0 nt lds
    buffer_load_dwordx4 v3, s[28:31], s58 offen offset:1024 nt lds
    buffer_load_dwordx4 v3, s[28:31], s58 offen offset:2048 nt lds
    buffer_load_dwordx4 v3, s[28:31], s58 offen offset:3072 nt lds
    s_waitcnt vmcnt(0)
    s_barrier
    ds_read_b128 a[208:211], v7 offset:0
    ds_read_b128 a[212:215], v8 offset:0
    ds_read_b128 a[216:219], v9 offset:0
    ds_read_b128 a[220:223], v10 offset:0
    ds_read_b128 a[224:227], v7 offset:1024
    ds_read_b128 a[228:231], v8 offset:1024
    ds_read_b128 a[232:235], v9 offset:1024
    ds_read_b128 a[236:239], v10 offset:1024
    s_waitcnt lgkmcnt(0)
    s_branch L_attn
.fill 2048, 4, 0xbf800000
.section .rodata,"a"
.p2align 6
.amdhsa_kernel standalone__mha_block_cached__near_ridge_kernel
  .amdhsa_next_free_vgpr 512
  .amdhsa_next_free_sgpr 102
  .amdhsa_accum_offset 256
  .amdhsa_group_segment_fixed_size 0
  .amdhsa_kernarg_size 64
  .amdhsa_user_sgpr_count 2
  .amdhsa_user_sgpr_kernarg_segment_ptr 1
  .amdhsa_system_sgpr_workgroup_id_x 1
.end_amdhsa_kernel
```
